```python
import torch

def _softmax(x, axis=-1):
    return torch.softmax(x, dim=axis)
def _gelu(x):
    return torch.nn.functional.gelu(x, approximate="tanh")
def _silu(x):
    return torch.nn.functional.silu(x)
def _sigmoid(x):
    return torch.sigmoid(x)
def _layernorm(x, axis=-1, eps=1e-5):
    m = x.mean(dim=axis, keepdim=True)
    v = x.var(dim=axis, keepdim=True, unbiased=False)
    return (x - m) / torch.sqrt(v + eps)
def _scatter_add(tgt, idx, src, axis=0):
    return tgt.clone().index_add_(axis, idx, src)
def _segment_sum(src, seg, n):
    out = torch.zeros((n,) + src.shape[1:], dtype=src.dtype)
    return out.index_add_(0, seg, src)
def _pad(x, pw):
    flat = tuple(v for pair in reversed(pw) for v in pair)
    return torch.nn.functional.pad(x, flat)

kernel_name = 'standalone__gqa_block_cached__near_ridge'

def setup_inputs():

    _w = (lambda a: (lambda t: t.to(torch.bfloat16) if t.is_floating_point() else t)(torch.as_tensor(a)))
    B, Sq, D = 8, 64, 576
    Hq, Hkv, Sk, Dh = 32, 16, 1024, 128
    assert Hq % Hkv == 0, (Hq, Hkv)
    return {
        "x": _w((lambda *s: torch.randn(*s, dtype=torch.bfloat16) * 0.8)(B, Sq, D)),
        "k_cache": _w((lambda *s: torch.randn(*s, dtype=torch.bfloat16) * 0.8)(B, Hkv, Sk, Dh)),
        "v_cache": _w((lambda *s: torch.randn(*s, dtype=torch.bfloat16) * 0.05)(B, Hkv, Sk, Dh)),
        "wq": _w((lambda *s: torch.randn(*s, dtype=torch.bfloat16) * 0.8)(D, Hq * Dh) * (D ** -0.5)),
        "wo": _w((lambda *s: torch.randn(*s, dtype=torch.bfloat16) * 0.05)(Hq * Dh, D) * ((Hq * Dh) ** -0.5)),
    }

def reference(x, k_cache, v_cache, wq, wo):
    B, Sq, D = x.shape
    Hq, Dh = 32, 128
    Hkv = k_cache.shape[1]
    rep = Hq // Hkv
    q = (lambda x, *d: x.permute(*d))((x @ wq).reshape(B, Sq, Hq, Dh), 0, 2, 1, 3)
    k = (lambda x, n, axis: torch.repeat_interleave(x, n, dim=axis))(k_cache, rep, axis=1)
    v = (lambda x, n, axis: torch.repeat_interleave(x, n, dim=axis))(v_cache, rep, axis=1)
    scores = torch.einsum("bhqd,bhkd->bhqk", q, k) * (Dh ** -0.5)
    p = _softmax(scores, axis=-1)
    o = torch.einsum("bhqk,bhkd->bhqd", p, v)
    return (lambda x, *d: x.permute(*d))(o, 0, 2, 1, 3).reshape(B, Sq, Hq * Dh) @ wo
```

```asm
; @launch grid=(256,1,1) block=(512,1,1) lds=163840
.amdgcn_target "amdgcn-amd-amdhsa--gfx950"
.text
.globl standalone__gqa_block_cached__near_ridge_kernel
.p2align 8
.type standalone__gqa_block_cached__near_ridge_kernel,@function
standalone__gqa_block_cached__near_ridge_kernel:
    s_cmp_ge_u32 s2, 256
    s_cbranch_scc1 K1_END
    s_load_dwordx4 s[4:7], s[0:1], 0
    s_load_dwordx4 s[8:11], s[0:1], 16
    s_load_dwordx2 s[12:13], s[0:1], 56
    s_load_dwordx2 s[14:15], s[0:1], 32
    s_load_dwordx4 s[80:83], s[0:1], 40
    s_getpc_b64 s[90:91]
K1_PCREF:
    s_mov_b32 s93, K1_END-K1_PCREF
    v_cmp_gt_u32 vcc, 6, v0
    s_and_saveexec_b64 s[58:59], vcc
    s_cbranch_execz K1_ICD
    s_lshr_b32 s92, s2, 3
    s_mul_i32 s92, s92, 768
    v_lshlrev_b32 v2, 7, v0
    v_add_u32 v2, s92, v2
    v_min_u32 v2, s93, v2
    global_load_dword v249, v2, s[90:91]
K1_ICD:
    s_mov_b64 exec, s[58:59]
    v_and_b32 v1, 63, v0
    v_lshrrev_b32 v2, 6, v0
    s_and_b32 s39, s2, 7
    s_lshr_b32 s50, s2, 3
    v_readfirstlane_b32 s36, v2
    s_lshr_b32 s37, s50, 2
    s_and_b32 s47, s50, 3
    s_lshl_b32 s38, s39, 2
    s_add_u32 s38, s38, s47
    s_lshl_b32 s54, s37, 5
    s_add_u32 s54, s54, s38
    v_and_b32 v2, 15, v1
    v_lshrrev_b32 v3, 4, v1
    v_lshrrev_b32 v4, 2, v2
    v_and_b32 v5, 3, v2
    v_lshrrev_b32 v6, 5, v1
    v_and_b32 v7, 31, v1
    s_cmp_lt_u32 s36, 4
    s_cbranch_scc1 K1_COMPUTE
    s_and_b32 s53, s36, 3
    s_lshl_b32 s56, s53, 12
    v_lshlrev_b32 v8, 2, v3
    v_xor_b32 v8, v8, v2
    v_lshlrev_b32 v8, 4, v8
    v_lshl_add_u32 v14, v3, 8, v8
    v_lshl_add_u32 v24, v3, 13, v8
    v_add_u32 v25, 31744, v24
    v_add_u32 v26, 63488, v24
    v_add_u32 v27, 95232, v24
    s_lshl_b32 s49, s53, 4
    s_movk_i32 s50, 1152
    v_lshrrev_b32 v8, 3, v1
    v_add_u32 v8, s49, v8
    v_add_u32 v8, 0, v8
    v_mul_lo_u32 v8, v8, s50
    v_add_u32 v9, 0, v3
    v_and_b32 v9, 7, v9
    v_and_b32 v28, 7, v1
    v_xor_b32 v9, v9, v28
    v_lshl_add_u32 v8, v9, 4, v8
    v_subrev_u32 v28, 0, v8
    v_lshrrev_b32 v8, 3, v1
    v_add_u32 v8, s49, v8
    v_add_u32 v8, 8, v8
    v_mul_lo_u32 v8, v8, s50
    v_add_u32 v9, 4, v3
    v_and_b32 v9, 7, v9
    v_and_b32 v29, 7, v1
    v_xor_b32 v9, v9, v29
    v_lshl_add_u32 v8, v9, 4, v8
    v_subrev_u32 v29, 1024, v8
    s_waitcnt lgkmcnt(0)
    s_lshl_b32 s49, s38, 8
    s_add_u32 s24, s10, s49
    s_addc_u32 s25, s11, 0
    s_sub_u32 s26, 4718592, s49
    s_mov_b32 s27, 0x20000
    s_mul_i32 s49, s37, 73728
    s_add_u32 s28, s4, s49
    s_addc_u32 s29, s5, 0
    s_mov_b32 s30, 73728
    s_mov_b32 s31, 0x20000
    s_cmp_eq_u32 s36, 4
    s_cbranch_scc0 K1_WT1
    v_lshrrev_b32 v8, 1, v1
    v_and_b32 v9, 1, v1
    v_lshlrev_b32 v8, 13, v8
    v_lshl_add_u32 v8, v9, 7, v8
    s_mul_i32 s49, s37, 589824
    buffer_load_dword v249, v8, s[24:27], s49 offen
    s_add_u32 s49, s49, 262144
    buffer_load_dword v249, v8, s[24:27], s49 offen
    s_add_u32 s49, s49, 262144
    v_cmp_gt_u32 vcc, 16, v1
    s_and_saveexec_b64 s[58:59], vcc
    buffer_load_dword v249, v8, s[24:27], s49 offen
    s_mov_b64 exec, s[58:59]
K1_WT1:
    s_cmp_eq_u32 s36, 5
    s_cbranch_scc0 K1_WT2
    v_lshlrev_b32 v9, 7, v1
    s_mul_i32 s49, s47, 18432
    buffer_load_dword v249, v9, s[28:31], s49 offen
    s_add_u32 s49, s49, 8192
    buffer_load_dword v249, v9, s[28:31], s49 offen
    s_add_u32 s49, s49, 8192
    v_cmp_gt_u32 vcc, 16, v1
    s_and_saveexec_b64 s[58:59], vcc
    buffer_load_dword v249, v9, s[28:31], s49 offen
    s_mov_b64 exec, s[58:59]
K1_WT2:
    s_lshl_b32 s49, s53, 17
    s_add_u32 s49, s49, 0
    s_add_u32 m0, s56, 139264
    s_nop 0
    buffer_load_dwordx4 v24, s[24:27], s49 offen offset:0 lds
    buffer_load_dwordx4 v25, s[24:27], s49 offen offset:1024 lds
    buffer_load_dwordx4 v26, s[24:27], s49 offen offset:2048 lds
    buffer_load_dwordx4 v27, s[24:27], s49 offen offset:3072 lds
    s_lshr_b32 s50, s56, 1
    s_add_u32 m0, s50, 155648
    s_movk_i32 s49, 0
    buffer_load_dwordx4 v28, s[28:31], s49 offen offset:0 lds
    buffer_load_dwordx4 v29, s[28:31], s49 offen offset:1024 lds
    s_lshl_b32 s49, s53, 17
    s_add_u32 s49, s49, 524288
    s_add_u32 m0, s56, 65536
    s_nop 0
    buffer_load_dwordx4 v24, s[24:27], s49 offen offset:0 lds
    buffer_load_dwordx4 v25, s[24:27], s49 offen offset:1024 lds
    buffer_load_dwordx4 v26, s[24:27], s49 offen offset:2048 lds
    buffer_load_dwordx4 v27, s[24:27], s49 offen offset:3072 lds
    s_lshr_b32 s50, s56, 1
    s_add_u32 m0, s50, 81920
    s_movk_i32 s49, 128
    buffer_load_dwordx4 v28, s[28:31], s49 offen offset:0 lds
    buffer_load_dwordx4 v29, s[28:31], s49 offen offset:1024 lds
    s_lshl_b32 s49, s53, 17
    s_add_u32 s49, s49, 1048576
    s_add_u32 m0, s56, 90112
    s_nop 0
    buffer_load_dwordx4 v24, s[24:27], s49 offen offset:0 lds
    buffer_load_dwordx4 v25, s[24:27], s49 offen offset:1024 lds
    buffer_load_dwordx4 v26, s[24:27], s49 offen offset:2048 lds
    buffer_load_dwordx4 v27, s[24:27], s49 offen offset:3072 lds
    s_lshr_b32 s50, s56, 1
    s_add_u32 m0, s50, 106496
    s_movk_i32 s49, 256
    buffer_load_dwordx4 v28, s[28:31], s49 offen offset:0 lds
    buffer_load_dwordx4 v29, s[28:31], s49 offen offset:1024 lds
    s_lshl_b32 s49, s53, 17
    s_add_u32 s49, s49, 1572864
    s_add_u32 m0, s56, 114688
    s_nop 0
    buffer_load_dwordx4 v24, s[24:27], s49 offen offset:0 lds
    buffer_load_dwordx4 v25, s[24:27], s49 offen offset:1024 lds
    buffer_load_dwordx4 v26, s[24:27], s49 offen offset:2048 lds
    buffer_load_dwordx4 v27, s[24:27], s49 offen offset:3072 lds
    s_lshr_b32 s50, s56, 1
    s_add_u32 m0, s50, 131072
    s_movk_i32 s49, 384
    buffer_load_dwordx4 v28, s[28:31], s49 offen offset:0 lds
    buffer_load_dwordx4 v29, s[28:31], s49 offen offset:1024 lds
    s_cmp_eq_u32 s2, 0
    s_cbranch_scc0 K1_NON
    s_cmp_eq_u32 s36, 7
    s_cbranch_scc0 K1_NON
    s_memrealtime s[84:85]
    s_waitcnt lgkmcnt(0)
    s_or_b32 s84, s84, 1
    v_mov_b32 v8, s84
    v_mov_b32 v9, s85
    v_mov_b32 v20, 0
    v_cmp_eq_u32 vcc, 0, v1
    s_and_saveexec_b64 s[58:59], vcc
    global_store_dwordx2 v20, v[8:9], s[82:83] sc1
    s_mov_b64 exec, s[58:59]
K1_NON:
    s_lshl_b32 s49, s37, 4
    s_lshr_b32 s50, s38, 1
    s_add_u32 s49, s49, s50
    s_lshl_b32 s49, s49, 18
    s_add_u32 s16, s6, s49
    s_addc_u32 s17, s7, 0
    s_mov_b32 s18, 0x40000
    s_mov_b32 s19, 0x20000
    s_add_u32 s20, s8, s49
    s_addc_u32 s21, s9, 0
    s_mov_b32 s22, 0x40000
    s_mov_b32 s23, 0x20000
    s_lshr_b32 s49, s53, 1
    s_lshl_b32 s94, s49, 17
    s_and_b32 s50, s53, 1
    s_lshl_b32 s57, s50, 12
    s_lshr_b32 s49, s38, 1
    s_mul_i32 s50, s37, 1
    s_mul_i32 s49, s49, 11
    s_add_u32 s49, s49, s50
    s_lshr_b32 s50, s53, 1
    s_mul_i32 s50, s50, 0
    s_add_u32 s49, s49, s50
    s_and_b32 s49, s49, 31
    s_lshl_b32 s49, s49, 12
    s_add_u32 s57, s57, s49
    v_add_u32 v8, 0, v3
    v_xor_b32 v8, v8, v2
    v_lshlrev_b32 v8, 4, v8
    v_lshl_add_u32 v10, v3, 8, v8
    v_add_u32 v8, 4, v3
    v_xor_b32 v8, v8, v2
    v_lshlrev_b32 v8, 4, v8
    v_lshl_add_u32 v11, v3, 8, v8
    v_add_u32 v8, 8, v3
    v_xor_b32 v8, v8, v2
    v_lshlrev_b32 v8, 4, v8
    v_lshl_add_u32 v12, v3, 8, v8
    v_add_u32 v8, 12, v3
    v_xor_b32 v8, v8, v2
    v_lshlrev_b32 v8, 4, v8
    v_lshl_add_u32 v13, v3, 8, v8
    s_movk_i32 s49, 3641
    s_movk_i32 s50, 1152
    s_add_u32 s51, s53, 0
    s_lshl_b32 s51, s51, 6
    v_add_u32 v8, s51, v1
    v_mul_u32_u24 v9, s49, v8
    v_lshrrev_b32 v9, 16, v9
    v_mul_u32_u24 v30, 18, v9
    v_sub_u32 v30, v8, v30
    v_mul_u32_u24 v9, s50, v9
    v_lshl_add_u32 v30, v30, 4, v9
    s_add_u32 s51, s53, 4
    s_lshl_b32 s51, s51, 6
    v_add_u32 v8, s51, v1
    v_mul_u32_u24 v9, s49, v8
    v_lshrrev_b32 v9, 16, v9
    v_mul_u32_u24 v31, 18, v9
    v_sub_u32 v31, v8, v31
    v_mul_u32_u24 v9, s50, v9
    v_lshl_add_u32 v31, v31, 4, v9
    v_add_u32 v8, 512, v1
    v_mul_u32_u24 v9, s49, v8
    v_lshrrev_b32 v9, 16, v9
    v_mul_u32_u24 v32, 18, v9
    v_sub_u32 v32, v8, v32
    v_mul_u32_u24 v9, s50, v9
    v_lshl_add_u32 v32, v32, 4, v9
    v_mov_b32 v240, 0
    v_mov_b32 v241, 0
    v_mov_b32 v242, 0
    v_mov_b32 v243, 0
    v_mov_b32 v244, 0
    v_mov_b32 v245, 0
    v_mov_b32 v246, 0
    v_mov_b32 v247, 0
    v_mov_b32 v248, 0
    s_waitcnt vmcnt(18)
    s_barrier
    s_waitcnt vmcnt(12)
    s_barrier
    s_lshl_b32 s49, s53, 17
    s_add_u32 s49, s49, 2097152
    s_add_u32 m0, s56, 139264
    s_nop 0
    buffer_load_dwordx4 v24, s[24:27], s49 offen offset:0 lds
    buffer_load_dwordx4 v25, s[24:27], s49 offen offset:1024 lds
    buffer_load_dwordx4 v26, s[24:27], s49 offen offset:2048 lds
    buffer_load_dwordx4 v27, s[24:27], s49 offen offset:3072 lds
    s_lshr_b32 s50, s56, 1
    s_add_u32 m0, s50, 155648
    s_movk_i32 s49, 512
    buffer_load_dwordx4 v28, s[28:31], s49 offen offset:0 lds
    buffer_load_dwordx4 v29, s[28:31], s49 offen offset:1024 lds
    s_waitcnt vmcnt(12)
    s_barrier
    s_lshl_b32 s49, s53, 17
    s_add_u32 s49, s49, 2621440
    s_add_u32 m0, s56, 65536
    s_nop 0
    buffer_load_dwordx4 v24, s[24:27], s49 offen offset:0 lds
    buffer_load_dwordx4 v25, s[24:27], s49 offen offset:1024 lds
    buffer_load_dwordx4 v26, s[24:27], s49 offen offset:2048 lds
    buffer_load_dwordx4 v27, s[24:27], s49 offen offset:3072 lds
    s_lshr_b32 s50, s56, 1
    s_add_u32 m0, s50, 81920
    s_movk_i32 s49, 640
    buffer_load_dwordx4 v28, s[28:31], s49 offen offset:0 lds
    buffer_load_dwordx4 v29, s[28:31], s49 offen offset:1024 lds
    s_waitcnt vmcnt(12)
    s_barrier
    s_lshl_b32 s49, s53, 17
    s_add_u32 s49, s49, 3145728
    s_add_u32 m0, s56, 90112
    s_nop 0
    buffer_load_dwordx4 v24, s[24:27], s49 offen offset:0 lds
    buffer_load_dwordx4 v25, s[24:27], s49 offen offset:1024 lds
    buffer_load_dwordx4 v26, s[24:27], s49 offen offset:2048 lds
    buffer_load_dwordx4 v27, s[24:27], s49 offen offset:3072 lds
    s_lshr_b32 s50, s56, 1
    s_add_u32 m0, s50, 106496
    s_movk_i32 s49, 768
    buffer_load_dwordx4 v28, s[28:31], s49 offen offset:0 lds
    buffer_load_dwordx4 v29, s[28:31], s49 offen offset:1024 lds
    s_waitcnt vmcnt(12)
    s_barrier
    s_lshl_b32 s49, s53, 17
    s_add_u32 s49, s49, 3670016
    s_add_u32 m0, s56, 114688
    s_nop 0
    buffer_load_dwordx4 v24, s[24:27], s49 offen offset:0 lds
    buffer_load_dwordx4 v25, s[24:27], s49 offen offset:1024 lds
    buffer_load_dwordx4 v26, s[24:27], s49 offen offset:2048 lds
    buffer_load_dwordx4 v27, s[24:27], s49 offen offset:3072 lds
    s_lshr_b32 s50, s56, 1
    s_add_u32 m0, s50, 131072
    s_movk_i32 s49, 896
    buffer_load_dwordx4 v28, s[28:31], s49 offen offset:0 lds
    buffer_load_dwordx4 v29, s[28:31], s49 offen offset:1024 lds
    s_waitcnt vmcnt(12)
    s_barrier
    s_lshl_b32 s49, s53, 17
    s_add_u32 s49, s49, 4194304
    s_add_u32 m0, s56, 139264
    s_nop 0
    buffer_load_dwordx4 v24, s[24:27], s49 offen offset:0 lds
    buffer_load_dwordx4 v25, s[24:27], s49 offen offset:1024 lds
    buffer_load_dwordx4 v26, s[24:27], s49 offen offset:2048 lds
    buffer_load_dwordx4 v27, s[24:27], s49 offen offset:3072 lds
    s_lshr_b32 s50, s56, 1
    s_add_u32 m0, s50, 155648
    s_movk_i32 s49, 1024
    buffer_load_dwordx4 v28, s[28:31], s49 offen offset:0 lds
    buffer_load_dwordx4 v29, s[28:31], s49 offen offset:1024 lds
    s_add_u32 s49, s57, 0
    s_and_b32 s49, s49, 131071
    s_or_b32 s49, s49, s94
    s_add_u32 m0, s56, 0
    s_nop 0
    buffer_load_dwordx4 v10, s[16:19], s49 offen offset:0 nt lds
    buffer_load_dwordx4 v11, s[16:19], s49 offen offset:1024 nt lds
    buffer_load_dwordx4 v12, s[16:19], s49 offen offset:2048 nt lds
    buffer_load_dwordx4 v13, s[16:19], s49 offen offset:3072 nt lds
    s_add_u32 s49, s57, 8192
    s_and_b32 s49, s49, 131071
    s_or_b32 s49, s49, s94
    s_add_u32 m0, s56, 16384
    s_nop 0
    buffer_load_dwordx4 v10, s[16:19], s49 offen offset:0 nt lds
    buffer_load_dwordx4 v11, s[16:19], s49 offen offset:1024 nt lds
    buffer_load_dwordx4 v12, s[16:19], s49 offen offset:2048 nt lds
    buffer_load_dwordx4 v13, s[16:19], s49 offen offset:3072 nt lds
    s_waitcnt vmcnt(20)
    s_barrier
    s_add_u32 s49, s57, 0
    s_and_b32 s49, s49, 131071
    s_or_b32 s49, s49, s94
    s_add_u32 m0, s56, 32768
    s_nop 0
    buffer_load_dwordx4 v14, s[20:23], s49 offen offset:0 nt lds
    buffer_load_dwordx4 v14, s[20:23], s49 offen offset:1024 nt lds
    buffer_load_dwordx4 v14, s[20:23], s49 offen offset:2048 nt lds
    buffer_load_dwordx4 v14, s[20:23], s49 offen offset:3072 nt lds
    s_add_u32 s49, s57, 16384
    s_and_b32 s49, s49, 131071
    s_or_b32 s49, s49, s94
    s_add_u32 m0, s56, 49152
    s_nop 0
    buffer_load_dwordx4 v10, s[16:19], s49 offen offset:0 nt lds
    buffer_load_dwordx4 v11, s[16:19], s49 offen offset:1024 nt lds
    buffer_load_dwordx4 v12, s[16:19], s49 offen offset:2048 nt lds
    buffer_load_dwordx4 v13, s[16:19], s49 offen offset:3072 nt lds
    s_waitcnt vmcnt(22)
    s_barrier
    s_waitcnt vmcnt(16)
    s_barrier
    s_barrier
    s_add_u32 s49, s57, 8192
    s_and_b32 s49, s49, 131071
    s_or_b32 s49, s49, s94
    s_add_u32 m0, s56, 65536
    s_nop 0
    buffer_load_dwordx4 v14, s[20:23], s49 offen offset:0 nt lds
    buffer_load_dwordx4 v14, s[20:23], s49 offen offset:1024 nt lds
    buffer_load_dwordx4 v14, s[20:23], s49 offen offset:2048 nt lds
    buffer_load_dwordx4 v14, s[20:23], s49 offen offset:3072 nt lds
    s_add_u32 s49, s57, 24576
    s_and_b32 s49, s49, 131071
    s_or_b32 s49, s49, s94
    s_add_u32 m0, s56, 81920
    s_nop 0
    buffer_load_dwordx4 v10, s[16:19], s49 offen offset:0 nt lds
    buffer_load_dwordx4 v11, s[16:19], s49 offen offset:1024 nt lds
    buffer_load_dwordx4 v12, s[16:19], s49 offen offset:2048 nt lds
    buffer_load_dwordx4 v13, s[16:19], s49 offen offset:3072 nt lds
    s_add_u32 s49, s57, 16384
    s_and_b32 s49, s49, 131071
    s_or_b32 s49, s49, s94
    s_add_u32 m0, s56, 98304
    s_nop 0
    buffer_load_dwordx4 v14, s[20:23], s49 offen offset:0 nt lds
    buffer_load_dwordx4 v14, s[20:23], s49 offen offset:1024 nt lds
    buffer_load_dwordx4 v14, s[20:23], s49 offen offset:2048 nt lds
    buffer_load_dwordx4 v14, s[20:23], s49 offen offset:3072 nt lds
    s_add_u32 s49, s57, 32768
    s_and_b32 s49, s49, 131071
    s_or_b32 s49, s49, s94
    s_add_u32 m0, s56, 114688
    s_nop 0
    buffer_load_dwordx4 v10, s[16:19], s49 offen offset:0 nt lds
    buffer_load_dwordx4 v11, s[16:19], s49 offen offset:1024 nt lds
    buffer_load_dwordx4 v12, s[16:19], s49 offen offset:2048 nt lds
    buffer_load_dwordx4 v13, s[16:19], s49 offen offset:3072 nt lds
    s_barrier
    s_waitcnt vmcnt(28)
    s_barrier
    s_add_u32 s49, s57, 24576
    s_and_b32 s49, s49, 131071
    s_or_b32 s49, s49, s94
    s_add_u32 m0, s56, 131072
    s_nop 0
    buffer_load_dwordx4 v14, s[20:23], s49 offen offset:0 nt lds
    buffer_load_dwordx4 v14, s[20:23], s49 offen offset:1024 nt lds
    buffer_load_dwordx4 v14, s[20:23], s49 offen offset:2048 nt lds
    buffer_load_dwordx4 v14, s[20:23], s49 offen offset:3072 nt lds
    s_waitcnt vmcnt(28)
    s_barrier
    s_add_u32 s49, s57, 40960
    s_and_b32 s49, s49, 131071
    s_or_b32 s49, s49, s94
    s_add_u32 m0, s56, 147456
    s_nop 0
    buffer_load_dwordx4 v10, s[16:19], s49 offen offset:0 nt lds
    buffer_load_dwordx4 v11, s[16:19], s49 offen offset:1024 nt lds
    buffer_load_dwordx4 v12, s[16:19], s49 offen offset:2048 nt lds
    buffer_load_dwordx4 v13, s[16:19], s49 offen offset:3072 nt lds
    s_and_b32 s98, s38, 0
    s_mov_b32 s55, 0
    s_mov_b32 s99, 16384
    s_add_u32 s45, s57, 32768
    s_and_b32 s45, s45, 131071
    s_or_b32 s45, s45, s94
    s_add_u32 s44, s57, 49152
    s_and_b32 s44, s44, 131071
    s_or_b32 s44, s44, s94
    s_mov_b32 s46, 0
    v_mov_b32 v40, v14
    v_mov_b32 v44, v10
    v_mov_b32 v41, v14
    v_mov_b32 v45, v11
    v_mov_b32 v42, v14
    v_mov_b32 v46, v12
    v_mov_b32 v43, v14
    v_mov_b32 v47, v13
K1_LLOOP:
    s_waitcnt vmcnt(28)
    s_barrier
    s_add_u32 m0, s55, s56
    s_nop 0
    buffer_load_dwordx4 v40, s[20:23], s45 offen offset:0 nt lds
    buffer_load_dwordx4 v41, s[20:23], s45 offen offset:1024 nt lds
    buffer_load_dwordx4 v42, s[20:23], s45 offen offset:2048 nt lds
    buffer_load_dwordx4 v43, s[20:23], s45 offen offset:3072 nt lds
    s_add_u32 s55, s55, 32768
    s_cmp_ge_u32 s55, 163840
    s_cselect_b32 s49, 163840, 0
    s_sub_u32 s55, s55, s49
    s_add_u32 s45, s45, 8192
    s_and_b32 s45, s45, 131071
    s_or_b32 s45, s45, s94
    s_waitcnt vmcnt(28)
    s_barrier
    s_add_u32 m0, s99, s56
    s_nop 0
    buffer_load_dwordx4 v44, s[16:19], s44 offen offset:0 nt lds
    buffer_load_dwordx4 v45, s[16:19], s44 offen offset:1024 nt lds
    buffer_load_dwordx4 v46, s[16:19], s44 offen offset:2048 nt lds
    buffer_load_dwordx4 v47, s[16:19], s44 offen offset:3072 nt lds
    s_add_u32 s99, s99, 32768
    s_cmp_ge_u32 s99, 163840
    s_cselect_b32 s49, 163840, 0
    s_sub_u32 s99, s99, s49
    s_add_u32 s44, s44, 8192
    s_and_b32 s44, s44, 131071
    s_or_b32 s44, s44, s94
    s_cmp_eq_u32 s46, 7
    s_cbranch_scc0 K1_WTT1
    s_cmp_eq_u32 s36, 6
    s_cbranch_scc0 K1_WOT2
    s_mul_i32 s49, s39, 589824
    s_add_u32 s28, s14, s49
    s_addc_u32 s29, s15, 0
    s_mov_b32 s30, 589824
    s_mov_b32 s31, 0x20000
    s_lshr_b32 s49, s2, 3
    s_mul_i32 s49, s49, 18432
    v_lshlrev_b32 v2, 7, v1
    buffer_load_dword v249, v2, s[28:31], s49 offen
    s_add_u32 s49, s49, 8192
    buffer_load_dword v249, v2, s[28:31], s49 offen
    s_add_u32 s49, s49, 8192
    v_cmp_gt_u32 vcc, 16, v1
    s_and_saveexec_b64 s[58:59], vcc
    buffer_load_dword v249, v2, s[28:31], s49 offen
    s_mov_b64 exec, s[58:59]
K1_WOT2:
K1_WTT1:
    s_add_u32 s46, s46, 1
    s_cmp_lt_u32 s46, 10
    s_cbranch_scc1 K1_LLOOP
    s_mul_i32 s49, s39, 589824
    s_mul_i32 s50, s47, 288
    s_add_u32 s49, s49, s50
    s_add_u32 s24, s14, s49
    s_addc_u32 s25, s15, 0
    s_sub_u32 s26, 4718592, s49
    s_mov_b32 s27, 0x20000
    s_cmp_eq_u32 s36, 7
    s_cbranch_scc0 K1_NL
    v_mov_b32 v8, 0
    global_load_dwordx2 v[20:21], v8, s[82:83] sc1
K1_NL:
    s_waitcnt vmcnt(28)
    s_barrier
    s_add_u32 s49, s57, 114688
    s_and_b32 s49, s49, 131071
    s_or_b32 s49, s49, s94
    s_add_u32 m0, s56, 0
    s_nop 0
    buffer_load_dwordx4 v14, s[20:23], s49 offen offset:0 nt lds
    buffer_load_dwordx4 v14, s[20:23], s49 offen offset:1024 nt lds
    buffer_load_dwordx4 v14, s[20:23], s49 offen offset:2048 nt lds
    buffer_load_dwordx4 v14, s[20:23], s49 offen offset:3072 nt lds
    s_waitcnt vmcnt(28)
    s_barrier
    s_waitcnt vmcnt(24)
    s_barrier
    s_add_u32 s49, s57, 122880
    s_and_b32 s49, s49, 131071
    s_or_b32 s49, s49, s94
    s_add_u32 m0, s56, 32768
    s_nop 0
    buffer_load_dwordx4 v14, s[20:23], s49 offen offset:0 nt lds
    buffer_load_dwordx4 v14, s[20:23], s49 offen offset:1024 nt lds
    buffer_load_dwordx4 v14, s[20:23], s49 offen offset:2048 nt lds
    buffer_load_dwordx4 v14, s[20:23], s49 offen offset:3072 nt lds
    s_lshl_b32 s50, s53, 10
    s_add_u32 m0, s50, 49152
    s_mov_b32 s49, 0
    buffer_load_dwordx4 v30, s[24:27], s49 offen lds
    s_add_u32 m0, s50, 53248
    s_cmp_eq_u32 s53, 0
    buffer_load_dwordx4 v31, s[24:27], s49 offen lds
    s_cbranch_scc0 K1_EG3
    s_mov_b32 m0, 57344
    s_nop 0
    buffer_load_dwordx4 v32, s[24:27], s49 offen lds
K1_EG3:
    s_waitcnt vmcnt(26)
    s_barrier
    s_lshl_b32 s50, s53, 10
    s_add_u32 m0, s50, 58368
    s_mov_b32 s49, 36864
    buffer_load_dwordx4 v30, s[24:27], s49 offen lds
    s_add_u32 m0, s50, 62464
    s_cmp_eq_u32 s53, 0
    buffer_load_dwordx4 v31, s[24:27], s49 offen lds
    s_cbranch_scc0 K1_EG4
    s_mov_b32 m0, 66560
    s_nop 0
    buffer_load_dwordx4 v32, s[24:27], s49 offen lds
K1_EG4:
    s_lshl_b32 s50, s53, 10
    s_add_u32 m0, s50, 67584
    s_mov_b32 s49, 73728
    buffer_load_dwordx4 v30, s[24:27], s49 offen lds
    s_add_u32 m0, s50, 71680
    s_cmp_eq_u32 s53, 0
    buffer_load_dwordx4 v31, s[24:27], s49 offen lds
    s_cbranch_scc0 K1_EG5
    s_mov_b32 m0, 75776
    s_nop 0
    buffer_load_dwordx4 v32, s[24:27], s49 offen lds
K1_EG5:
    s_waitcnt vmcnt(26)
    s_barrier
    s_lshl_b32 s50, s53, 10
    s_add_u32 m0, s50, 76800
    s_mov_b32 s49, 110592
    buffer_load_dwordx4 v30, s[24:27], s49 offen lds
    s_add_u32 m0, s50, 80896
    s_cmp_eq_u32 s53, 0
    buffer_load_dwordx4 v31, s[24:27], s49 offen lds
    s_cbranch_scc0 K1_EG6
    s_mov_b32 m0, 84992
    s_nop 0
    buffer_load_dwordx4 v32, s[24:27], s49 offen lds
K1_EG6:
    s_lshl_b32 s50, s53, 10
    s_add_u32 m0, s50, 86016
    s_mov_b32 s49, 147456
    buffer_load_dwordx4 v30, s[24:27], s49 offen lds
    s_add_u32 m0, s50, 90112
    s_cmp_eq_u32 s53, 0
    buffer_load_dwordx4 v31, s[24:27], s49 offen lds
    s_cbranch_scc0 K1_EG7
    s_mov_b32 m0, 94208
    s_nop 0
    buffer_load_dwordx4 v32, s[24:27], s49 offen lds
K1_EG7:
    s_waitcnt vmcnt(26)
    s_barrier
    s_lshl_b32 s50, s53, 10
    s_add_u32 m0, s50, 95232
    s_mov_b32 s49, 184320
    buffer_load_dwordx4 v30, s[24:27], s49 offen lds
    s_add_u32 m0, s50, 99328
    s_cmp_eq_u32 s53, 0
    buffer_load_dwordx4 v31, s[24:27], s49 offen lds
    s_cbranch_scc0 K1_EG8
    s_mov_b32 m0, 103424
    s_nop 0
    buffer_load_dwordx4 v32, s[24:27], s49 offen lds
K1_EG8:
    s_lshl_b32 s50, s53, 10
    s_add_u32 m0, s50, 104448
    s_mov_b32 s49, 221184
    buffer_load_dwordx4 v30, s[24:27], s49 offen lds
    s_add_u32 m0, s50, 108544
    s_cmp_eq_u32 s53, 0
    buffer_load_dwordx4 v31, s[24:27], s49 offen lds
    s_cbranch_scc0 K1_EG9
    s_mov_b32 m0, 112640
    s_nop 0
    buffer_load_dwordx4 v32, s[24:27], s49 offen lds
K1_EG9:
    s_waitcnt vmcnt(26)
    s_barrier
    s_lshl_b32 s50, s53, 10
    s_add_u32 m0, s50, 113664
    s_mov_b32 s49, 258048
    buffer_load_dwordx4 v30, s[24:27], s49 offen lds
    s_add_u32 m0, s50, 117760
    s_cmp_eq_u32 s53, 0
    buffer_load_dwordx4 v31, s[24:27], s49 offen lds
    s_cbranch_scc0 K1_EG10
    s_mov_b32 m0, 121856
    s_nop 0
    buffer_load_dwordx4 v32, s[24:27], s49 offen lds
K1_EG10:
    s_waitcnt vmcnt(24)
    s_barrier
    s_lshl_b32 s50, s53, 10
    s_add_u32 m0, s50, 122880
    s_mov_b32 s49, 294912
    buffer_load_dwordx4 v30, s[24:27], s49 offen lds
    s_add_u32 m0, s50, 126976
    s_cmp_eq_u32 s53, 0
    buffer_load_dwordx4 v31, s[24:27], s49 offen lds
    s_cbranch_scc0 K1_EG11
    s_mov_b32 m0, 131072
    s_nop 0
    buffer_load_dwordx4 v32, s[24:27], s49 offen lds
K1_EG11:
    s_lshl_b32 s50, s53, 10
    s_add_u32 m0, s50, 132096
    s_mov_b32 s49, 331776
    buffer_load_dwordx4 v30, s[24:27], s49 offen lds
    s_add_u32 m0, s50, 136192
    s_cmp_eq_u32 s53, 0
    buffer_load_dwordx4 v31, s[24:27], s49 offen lds
    s_cbranch_scc0 K1_EG12
    s_mov_b32 m0, 140288
    s_nop 0
    buffer_load_dwordx4 v32, s[24:27], s49 offen lds
K1_EG12:
    s_waitcnt vmcnt(24)
    s_barrier
    s_lshl_b32 s50, s53, 10
    s_add_u32 m0, s50, 141312
    s_mov_b32 s49, 368640
    buffer_load_dwordx4 v30, s[24:27], s49 offen lds
    s_add_u32 m0, s50, 145408
    s_cmp_eq_u32 s53, 0
    buffer_load_dwordx4 v31, s[24:27], s49 offen lds
    s_cbranch_scc0 K1_EG13
    s_mov_b32 m0, 149504
    s_nop 0
    buffer_load_dwordx4 v32, s[24:27], s49 offen lds
K1_EG13:
    s_lshl_b32 s50, s53, 10
    s_add_u32 m0, s50, 150528
    s_mov_b32 s49, 405504
    buffer_load_dwordx4 v30, s[24:27], s49 offen lds
    s_add_u32 m0, s50, 154624
    s_cmp_eq_u32 s53, 0
    buffer_load_dwordx4 v31, s[24:27], s49 offen lds
    s_cbranch_scc0 K1_EG14
    s_mov_b32 m0, 158720
    s_nop 0
    buffer_load_dwordx4 v32, s[24:27], s49 offen lds
K1_EG14:
    s_waitcnt vmcnt(24)
    s_barrier
    s_mov_b32 s32, s12
    s_mov_b32 s33, s13
    s_mov_b32 s34, 17825792
    s_mov_b32 s35, 0x20000
    s_barrier
    s_cmp_eq_u32 s36, 7
    s_cbranch_scc0 K1_NON2
    s_waitcnt vmcnt(0)
    s_mov_b32 s51, 0
K1_NONP:
    v_readfirstlane_b32 s49, v20
    s_add_u32 s51, s51, 1
    s_cmp_lg_u32 s49, 0
    s_cbranch_scc1 K1_NONOK
    s_cmp_lt_u32 s51, 262144
    s_cbranch_scc0 K1_NONOK
    v_mov_b32 v8, 0
    global_load_dwordx2 v[20:21], v8, s[82:83] sc1
    s_waitcnt vmcnt(0)
    s_branch K1_NONP
K1_NONOK:
    v_mov_b32 v6, 38912
    ds_write_b64 v6, v[20:21]
    s_and_b32 s49, s54, 0xfc
    s_lshl_b32 s49, s49, 7
    s_add_u32 s49, s49, 16777216
    v_and_b32 v12, 3, v1
    v_lshlrev_b32 v13, 7, v12
    buffer_load_dword v11, v13, s[32:35], s49 offen sc1
    s_waitcnt lgkmcnt(0)
K1_NON2:
    s_barrier
    v_mov_b32 v6, 38912
    ds_read_b64 v[8:9], v6
    s_cmp_eq_u32 s36, 7
    s_cbranch_scc0 K1_RDY
    s_waitcnt vmcnt(0)
    v_cmp_eq_u32 vcc, v11, v20
    v_cmp_eq_u32 s[58:59], s47, v12
    s_or_b64 vcc, vcc, s[58:59]
    s_cmp_eq_u64 vcc, -1
    s_cselect_b32 s49, 1, 0
    v_mov_b32 v12, s49
    v_mov_b32 v6, 38920
    ds_write_b32 v6, v12
K1_RDY:
    s_barrier
    s_lshl_b32 s50, s53, 10
    s_add_u32 m0, s50, 0
    s_mov_b32 s49, 442368
    buffer_load_dwordx4 v30, s[24:27], s49 offen lds
    s_add_u32 m0, s50, 4096
    s_cmp_eq_u32 s53, 0
    buffer_load_dwordx4 v31, s[24:27], s49 offen lds
    s_cbranch_scc0 K1_EG15
    s_mov_b32 m0, 8192
    s_nop 0
    buffer_load_dwordx4 v32, s[24:27], s49 offen lds
K1_EG15:
    s_lshl_b32 s50, s53, 10
    s_add_u32 m0, s50, 9216
    s_mov_b32 s49, 479232
    buffer_load_dwordx4 v30, s[24:27], s49 offen lds
    s_add_u32 m0, s50, 13312
    s_cmp_eq_u32 s53, 0
    buffer_load_dwordx4 v31, s[24:27], s49 offen lds
    s_cbranch_scc0 K1_EG16
    s_mov_b32 m0, 17408
    s_nop 0
    buffer_load_dwordx4 v32, s[24:27], s49 offen lds
K1_EG16:
    s_lshl_b32 s50, s53, 10
    s_add_u32 m0, s50, 18432
    s_mov_b32 s49, 516096
    buffer_load_dwordx4 v30, s[24:27], s49 offen lds
    s_add_u32 m0, s50, 22528
    s_cmp_eq_u32 s53, 0
    buffer_load_dwordx4 v31, s[24:27], s49 offen lds
    s_cbranch_scc0 K1_EG17
    s_mov_b32 m0, 26624
    s_nop 0
    buffer_load_dwordx4 v32, s[24:27], s49 offen lds
K1_EG17:
    s_lshl_b32 s50, s53, 10
    s_add_u32 m0, s50, 27648
    s_mov_b32 s49, 552960
    buffer_load_dwordx4 v30, s[24:27], s49 offen lds
    s_add_u32 m0, s50, 31744
    s_cmp_eq_u32 s53, 0
    buffer_load_dwordx4 v31, s[24:27], s49 offen lds
    s_cbranch_scc0 K1_EG18
    s_mov_b32 m0, 35840
    s_nop 0
    buffer_load_dwordx4 v32, s[24:27], s49 offen lds
K1_EG18:
    s_branch K1_TAIL
K1_COMPUTE:
    s_and_b32 s40, s36, 1
    s_lshr_b32 s41, s36, 1
    s_mov_b32 s48, 0x3e0293ee
    v_lshl_add_u32 v8, v6, 3, v4
    v_lshlrev_b32 v8, 8, v8
    v_lshrrev_b32 v9, 1, v5
    v_lshl_add_u32 v8, v9, 3, v8
    v_and_b32 v9, 1, v3
    v_lshlrev_b32 v9, 1, v9
    v_and_b32 v2, 1, v5
    v_add_u32 v9, v9, v2
    v_lshlrev_b32 v2, 2, v4
    s_lshl_b32 s49, s41, 3
    v_add_u32 v19, s49, v9
    v_xor_b32 v19, v19, v2
    v_lshl_add_u32 v10, v19, 4, v8
    s_add_u32 s49, s49, 4
    v_add_u32 v19, s49, v9
    v_xor_b32 v19, v19, v2
    v_lshl_add_u32 v11, v19, 4, v8
    s_add_u32 s49, s49, 4
    s_lshl_b32 s49, s40, 5
    v_add_u32 v8, s49, v7
    v_lshrrev_b32 v9, 1, v8
    v_and_b32 v9, 7, v9
    v_xor_b32 v9, v9, v6
    v_lshlrev_b32 v9, 4, v9
    v_lshl_add_u32 v12, v8, 7, v9
    s_lshl_b32 s49, s41, 5
    v_add_u32 v8, s49, v7
    v_and_b32 v9, 15, v8
    v_xor_b32 v9, v9, v6
    v_lshlrev_b32 v9, 4, v9
    v_lshl_add_u32 v13, v8, 8, v9
    v_lshl_add_u32 v8, v6, 2, v4
    v_add_u32 v8, s49, v8
    v_lshlrev_b32 v8, 8, v8
    v_and_b32 v9, 1, v5
    v_lshl_add_u32 v8, v9, 3, v8
    v_and_b32 v9, 1, v3
    v_lshlrev_b32 v9, 1, v9
    v_lshrrev_b32 v2, 1, v5
    v_add_u32 v9, v9, v2
    v_lshlrev_b32 v2, 2, v4
    s_lshl_b32 s50, s41, 1
    s_add_u32 s50, s50, 0
    s_and_b32 s50, s50, 3
    s_lshl_b32 s50, s50, 2
    v_add_u32 v19, s50, v9
    v_xor_b32 v19, v19, v2
    v_lshl_add_u32 v24, v19, 4, v8
    s_lshl_b32 s50, s41, 1
    s_add_u32 s50, s50, 1
    s_and_b32 s50, s50, 3
    s_lshl_b32 s50, s50, 2
    v_add_u32 v19, s50, v9
    v_xor_b32 v19, v19, v2
    v_lshl_add_u32 v25, v19, 4, v8
    s_lshl_b32 s50, s41, 1
    s_add_u32 s50, s50, 2
    s_and_b32 s50, s50, 3
    s_lshl_b32 s50, s50, 2
    v_add_u32 v19, s50, v9
    v_xor_b32 v19, v19, v2
    v_lshl_add_u32 v26, v19, 4, v8
    s_lshl_b32 s50, s41, 1
    s_add_u32 s50, s50, 3
    s_and_b32 s50, s50, 3
    s_lshl_b32 s50, s50, 2
    v_add_u32 v19, s50, v9
    v_xor_b32 v19, v19, v2
    v_lshl_add_u32 v27, v19, 4, v8
    v_mov_b32 v72, 0
    v_mov_b32 v73, 0
    v_mov_b32 v74, 0
    v_mov_b32 v75, 0
    v_mov_b32 v76, 0
    v_mov_b32 v77, 0
    v_mov_b32 v78, 0
    v_mov_b32 v79, 0
    v_mov_b32 v80, 0
    v_mov_b32 v81, 0
    v_mov_b32 v82, 0
    v_mov_b32 v83, 0
    v_mov_b32 v84, 0
    v_mov_b32 v85, 0
    v_mov_b32 v86, 0
    v_mov_b32 v87, 0
    v_mov_b32 v88, 0
    v_mov_b32 v89, 0
    v_mov_b32 v90, 0
    v_mov_b32 v91, 0
    v_mov_b32 v92, 0
    v_mov_b32 v93, 0
    v_mov_b32 v94, 0
    v_mov_b32 v95, 0
    v_mov_b32 v96, 0
    v_mov_b32 v97, 0
    v_mov_b32 v98, 0
    v_mov_b32 v99, 0
    v_mov_b32 v100, 0
    v_mov_b32 v101, 0
    v_mov_b32 v102, 0
    v_mov_b32 v103, 0
    v_mov_b32 v36, 0xf149f2ca
    v_mov_b32 v37, 0xf149f2ca
    v_mov_b32 v38, 0
    v_mov_b32 v39, 0
    s_movk_i32 s49, 3641
    s_movk_i32 s50, 1152
    v_add_u32 v2, 0, v1
    v_mul_u32_u24 v3, s49, v2
    v_lshrrev_b32 v3, 16, v3
    v_mul_u32_u24 v4, 18, v3
    v_sub_u32 v4, v2, v4
    v_mul_u32_u24 v3, s50, v3
    v_lshl_add_u32 v3, v4, 4, v3
    v_subrev_u32 v240, 0, v3
    v_add_u32 v2, 64, v1
    v_mul_u32_u24 v3, s49, v2
    v_lshrrev_b32 v3, 16, v3
    v_mul_u32_u24 v4, 18, v3
    v_sub_u32 v4, v2, v4
    v_mul_u32_u24 v3, s50, v3
    v_lshl_add_u32 v3, v4, 4, v3
    v_subrev_u32 v241, 1024, v3
    v_add_u32 v2, 128, v1
    v_mul_u32_u24 v3, s49, v2
    v_lshrrev_b32 v3, 16, v3
    v_mul_u32_u24 v4, 18, v3
    v_sub_u32 v4, v2, v4
    v_mul_u32_u24 v3, s50, v3
    v_lshl_add_u32 v3, v4, 4, v3
    v_subrev_u32 v242, 2048, v3
    v_add_u32 v2, 192, v1
    v_mul_u32_u24 v3, s49, v2
    v_lshrrev_b32 v3, 16, v3
    v_mul_u32_u24 v4, 18, v3
    v_sub_u32 v4, v2, v4
    v_mul_u32_u24 v3, s50, v3
    v_lshl_add_u32 v3, v4, 4, v3
    v_subrev_u32 v243, 3072, v3
    v_add_u32 v2, 256, v1
    v_mul_u32_u24 v3, s49, v2
    v_lshrrev_b32 v3, 16, v3
    v_mul_u32_u24 v4, 18, v3
    v_sub_u32 v4, v2, v4
    v_mul_u32_u24 v3, s50, v3
    v_lshl_add_u32 v3, v4, 4, v3
    v_subrev_u32 v244, 0, v3
    v_add_u32 v2, 320, v1
    v_mul_u32_u24 v3, s49, v2
    v_lshrrev_b32 v3, 16, v3
    v_mul_u32_u24 v4, 18, v3
    v_sub_u32 v4, v2, v4
    v_mul_u32_u24 v3, s50, v3
    v_lshl_add_u32 v3, v4, 4, v3
    v_subrev_u32 v245, 1024, v3
    v_add_u32 v2, 384, v1
    v_mul_u32_u24 v3, s49, v2
    v_lshrrev_b32 v3, 16, v3
    v_mul_u32_u24 v4, 18, v3
    v_sub_u32 v4, v2, v4
    v_mul_u32_u24 v3, s50, v3
    v_lshl_add_u32 v3, v4, 4, v3
    v_subrev_u32 v246, 2048, v3
    v_add_u32 v2, 448, v1
    v_mul_u32_u24 v3, s49, v2
    v_lshrrev_b32 v3, 16, v3
    v_mul_u32_u24 v4, 18, v3
    v_sub_u32 v4, v2, v4
    v_mul_u32_u24 v3, s50, v3
    v_lshl_add_u32 v3, v4, 4, v3
    v_subrev_u32 v247, 3072, v3
    v_add_u32 v2, 512, v1
    v_mul_u32_u24 v3, s49, v2
    v_lshrrev_b32 v3, 16, v3
    v_mul_u32_u24 v4, 18, v3
    v_sub_u32 v4, v2, v4
    v_mul_u32_u24 v3, s50, v3
    v_lshl_add_u32 v3, v4, 4, v3
    v_subrev_u32 v248, 0, v3
    s_waitcnt lgkmcnt(0)
    v_add_u32 v28, 139264, v10
    v_add_u32 v29, 139264, v11
    v_add_u32 v30, 155648, v12
    v_xor_b32 v31, 32, v30
    v_xor_b32 v32, 64, v30
    v_xor_b32 v33, 96, v30
    s_waitcnt lgkmcnt(0)
    s_barrier
    ds_read_b64_tr_b16 v[112:113], v28 offset:0
    ds_read_b64_tr_b16 v[114:115], v28 offset:1024
    ds_read_b64_tr_b16 v[116:117], v29 offset:0
    ds_read_b64_tr_b16 v[118:119], v29 offset:1024
    ds_read_b128 v[120:123], v30
    ds_read_b64_tr_b16 v[124:125], v28 offset:4096
    ds_read_b64_tr_b16 v[126:127], v28 offset:5120
    ds_read_b64_tr_b16 v[128:129], v29 offset:4096
    ds_read_b64_tr_b16 v[130:131], v29 offset:5120
    ds_read_b128 v[132:135], v31
    ds_read_b64_tr_b16 v[136:137], v28 offset:8192
    ds_read_b64_tr_b16 v[138:139], v28 offset:9216
    ds_read_b64_tr_b16 v[140:141], v29 offset:8192
    ds_read_b64_tr_b16 v[142:143], v29 offset:9216
    ds_read_b128 v[144:147], v32
    ds_read_b64_tr_b16 v[148:149], v28 offset:12288
    ds_read_b64_tr_b16 v[150:151], v28 offset:13312
    ds_read_b64_tr_b16 v[152:153], v29 offset:12288
    ds_read_b64_tr_b16 v[154:155], v29 offset:13312
    ds_read_b128 v[156:159], v33
    v_add_u32 v28, 65536, v10
    v_add_u32 v29, 65536, v11
    v_add_u32 v30, 81920, v12
    v_xor_b32 v31, 32, v30
    v_xor_b32 v32, 64, v30
    v_xor_b32 v33, 96, v30
    s_waitcnt lgkmcnt(0)
    s_barrier
    v_mfma_f32_32x32x16_bf16 v[72:87], v[112:115], v[120:123], v[72:87]
    ds_read_b64_tr_b16 v[176:177], v28 offset:0
    ds_read_b64_tr_b16 v[178:179], v28 offset:1024
    ds_read_b64_tr_b16 v[180:181], v29 offset:0
    v_mfma_f32_32x32x16_bf16 v[88:103], v[116:119], v[120:123], v[88:103]
    ds_read_b64_tr_b16 v[182:183], v29 offset:1024
    ds_read_b128 v[184:187], v30
    v_mfma_f32_32x32x16_bf16 v[72:87], v[124:127], v[132:135], v[72:87]
    ds_read_b64_tr_b16 v[188:189], v28 offset:4096
    ds_read_b64_tr_b16 v[190:191], v28 offset:5120
    ds_read_b64_tr_b16 v[192:193], v29 offset:4096
    v_mfma_f32_32x32x16_bf16 v[88:103], v[128:131], v[132:135], v[88:103]
    ds_read_b64_tr_b16 v[194:195], v29 offset:5120
    ds_read_b128 v[196:199], v31
    v_mfma_f32_32x32x16_bf16 v[72:87], v[136:139], v[144:147], v[72:87]
    ds_read_b64_tr_b16 v[200:201], v28 offset:8192
    ds_read_b64_tr_b16 v[202:203], v28 offset:9216
    ds_read_b64_tr_b16 v[204:205], v29 offset:8192
    v_mfma_f32_32x32x16_bf16 v[88:103], v[140:143], v[144:147], v[88:103]
    ds_read_b64_tr_b16 v[206:207], v29 offset:9216
    ds_read_b128 v[208:211], v32
    v_mfma_f32_32x32x16_bf16 v[72:87], v[148:151], v[156:159], v[72:87]
    ds_read_b64_tr_b16 v[212:213], v28 offset:12288
    ds_read_b64_tr_b16 v[214:215], v28 offset:13312
    ds_read_b64_tr_b16 v[216:217], v29 offset:12288
    v_mfma_f32_32x32x16_bf16 v[88:103], v[152:155], v[156:159], v[88:103]
    ds_read_b64_tr_b16 v[218:219], v29 offset:13312
    ds_read_b128 v[220:223], v33
    v_add_u32 v28, 90112, v10
    v_add_u32 v29, 90112, v11
    v_add_u32 v30, 106496, v12
    v_xor_b32 v31, 32, v30
    v_xor_b32 v32, 64, v30
    v_xor_b32 v33, 96, v30
    s_waitcnt lgkmcnt(0)
    s_barrier
    v_mfma_f32_32x32x16_bf16 v[72:87], v[176:179], v[184:187], v[72:87]
    ds_read_b64_tr_b16 v[112:113], v28 offset:0
    ds_read_b64_tr_b16 v[114:115], v28 offset:1024
    ds_read_b64_tr_b16 v[116:117], v29 offset:0
    v_mfma_f32_32x32x16_bf16 v[88:103], v[180:183], v[184:187], v[88:103]
    ds_read_b64_tr_b16 v[118:119], v29 offset:1024
    ds_read_b128 v[120:123], v30
    v_mfma_f32_32x32x16_bf16 v[72:87], v[188:191], v[196:199], v[72:87]
    ds_read_b64_tr_b16 v[124:125], v28 offset:4096
    ds_read_b64_tr_b16 v[126:127], v28 offset:5120
    ds_read_b64_tr_b16 v[128:129], v29 offset:4096
    v_mfma_f32_32x32x16_bf16 v[88:103], v[192:195], v[196:199], v[88:103]
    ds_read_b64_tr_b16 v[130:131], v29 offset:5120
    ds_read_b128 v[132:135], v31
    v_mfma_f32_32x32x16_bf16 v[72:87], v[200:203], v[208:211], v[72:87]
    ds_read_b64_tr_b16 v[136:137], v28 offset:8192
    ds_read_b64_tr_b16 v[138:139], v28 offset:9216
    ds_read_b64_tr_b16 v[140:141], v29 offset:8192
    v_mfma_f32_32x32x16_bf16 v[88:103], v[204:207], v[208:211], v[88:103]
    ds_read_b64_tr_b16 v[142:143], v29 offset:9216
    ds_read_b128 v[144:147], v32
    v_mfma_f32_32x32x16_bf16 v[72:87], v[212:215], v[220:223], v[72:87]
    ds_read_b64_tr_b16 v[148:149], v28 offset:12288
    ds_read_b64_tr_b16 v[150:151], v28 offset:13312
    ds_read_b64_tr_b16 v[152:153], v29 offset:12288
    v_mfma_f32_32x32x16_bf16 v[88:103], v[216:219], v[220:223], v[88:103]
    ds_read_b64_tr_b16 v[154:155], v29 offset:13312
    ds_read_b128 v[156:159], v33
    v_add_u32 v28, 114688, v10
    v_add_u32 v29, 114688, v11
    v_add_u32 v30, 131072, v12
    v_xor_b32 v31, 32, v30
    v_xor_b32 v32, 64, v30
    v_xor_b32 v33, 96, v30
    s_waitcnt lgkmcnt(0)
    s_barrier
    v_mfma_f32_32x32x16_bf16 v[72:87], v[112:115], v[120:123], v[72:87]
    ds_read_b64_tr_b16 v[176:177], v28 offset:0
    ds_read_b64_tr_b16 v[178:179], v28 offset:1024
    ds_read_b64_tr_b16 v[180:181], v29 offset:0
    v_mfma_f32_32x32x16_bf16 v[88:103], v[116:119], v[120:123], v[88:103]
    ds_read_b64_tr_b16 v[182:183], v29 offset:1024
    ds_read_b128 v[184:187], v30
    v_mfma_f32_32x32x16_bf16 v[72:87], v[124:127], v[132:135], v[72:87]
    ds_read_b64_tr_b16 v[188:189], v28 offset:4096
    ds_read_b64_tr_b16 v[190:191], v28 offset:5120
    ds_read_b64_tr_b16 v[192:193], v29 offset:4096
    v_mfma_f32_32x32x16_bf16 v[88:103], v[128:131], v[132:135], v[88:103]
    ds_read_b64_tr_b16 v[194:195], v29 offset:5120
    ds_read_b128 v[196:199], v31
    v_mfma_f32_32x32x16_bf16 v[72:87], v[136:139], v[144:147], v[72:87]
    ds_read_b64_tr_b16 v[200:201], v28 offset:8192
    ds_read_b64_tr_b16 v[202:203], v28 offset:9216
    ds_read_b64_tr_b16 v[204:205], v29 offset:8192
    v_mfma_f32_32x32x16_bf16 v[88:103], v[140:143], v[144:147], v[88:103]
    ds_read_b64_tr_b16 v[206:207], v29 offset:9216
    ds_read_b128 v[208:211], v32
    v_mfma_f32_32x32x16_bf16 v[72:87], v[148:151], v[156:159], v[72:87]
    ds_read_b64_tr_b16 v[212:213], v28 offset:12288
    ds_read_b64_tr_b16 v[214:215], v28 offset:13312
    ds_read_b64_tr_b16 v[216:217], v29 offset:12288
    v_mfma_f32_32x32x16_bf16 v[88:103], v[152:155], v[156:159], v[88:103]
    ds_read_b64_tr_b16 v[218:219], v29 offset:13312
    ds_read_b128 v[220:223], v33
    v_add_u32 v28, 139264, v10
    v_add_u32 v29, 139264, v11
    v_add_u32 v30, 155648, v12
    v_xor_b32 v31, 32, v30
    v_xor_b32 v32, 64, v30
    v_xor_b32 v33, 96, v30
    s_waitcnt lgkmcnt(0)
    s_barrier
    v_mfma_f32_32x32x16_bf16 v[72:87], v[176:179], v[184:187], v[72:87]
    ds_read_b64_tr_b16 v[112:113], v28 offset:0
    ds_read_b64_tr_b16 v[114:115], v28 offset:1024
    ds_read_b64_tr_b16 v[116:117], v29 offset:0
    v_mfma_f32_32x32x16_bf16 v[88:103], v[180:183], v[184:187], v[88:103]
    ds_read_b64_tr_b16 v[118:119], v29 offset:1024
    ds_read_b128 v[120:123], v30
    v_mfma_f32_32x32x16_bf16 v[72:87], v[188:191], v[196:199], v[72:87]
    ds_read_b64_tr_b16 v[124:125], v28 offset:4096
    ds_read_b64_tr_b16 v[126:127], v28 offset:5120
    ds_read_b64_tr_b16 v[128:129], v29 offset:4096
    v_mfma_f32_32x32x16_bf16 v[88:103], v[192:195], v[196:199], v[88:103]
    ds_read_b64_tr_b16 v[130:131], v29 offset:5120
    ds_read_b128 v[132:135], v31
    v_mfma_f32_32x32x16_bf16 v[72:87], v[200:203], v[208:211], v[72:87]
    ds_read_b64_tr_b16 v[136:137], v28 offset:8192
    ds_read_b64_tr_b16 v[138:139], v28 offset:9216
    ds_read_b64_tr_b16 v[140:141], v29 offset:8192
    v_mfma_f32_32x32x16_bf16 v[88:103], v[204:207], v[208:211], v[88:103]
    ds_read_b64_tr_b16 v[142:143], v29 offset:9216
    ds_read_b128 v[144:147], v32
    v_mfma_f32_32x32x16_bf16 v[72:87], v[212:215], v[220:223], v[72:87]
    ds_read_b64_tr_b16 v[148:149], v28 offset:12288
    ds_read_b64_tr_b16 v[150:151], v28 offset:13312
    ds_read_b64_tr_b16 v[152:153], v29 offset:12288
    v_mfma_f32_32x32x16_bf16 v[88:103], v[216:219], v[220:223], v[88:103]
    ds_read_b64_tr_b16 v[154:155], v29 offset:13312
    ds_read_b128 v[156:159], v33
    v_add_u32 v28, 65536, v10
    v_add_u32 v29, 65536, v11
    v_add_u32 v30, 81920, v12
    v_xor_b32 v31, 32, v30
    v_xor_b32 v32, 64, v30
    v_xor_b32 v33, 96, v30
    s_waitcnt lgkmcnt(0)
    s_barrier
    v_mfma_f32_32x32x16_bf16 v[72:87], v[112:115], v[120:123], v[72:87]
    ds_read_b64_tr_b16 v[176:177], v28 offset:0
    ds_read_b64_tr_b16 v[178:179], v28 offset:1024
    ds_read_b64_tr_b16 v[180:181], v29 offset:0
    v_mfma_f32_32x32x16_bf16 v[88:103], v[116:119], v[120:123], v[88:103]
    ds_read_b64_tr_b16 v[182:183], v29 offset:1024
    ds_read_b128 v[184:187], v30
    v_mfma_f32_32x32x16_bf16 v[72:87], v[124:127], v[132:135], v[72:87]
    ds_read_b64_tr_b16 v[188:189], v28 offset:4096
    ds_read_b64_tr_b16 v[190:191], v28 offset:5120
    ds_read_b64_tr_b16 v[192:193], v29 offset:4096
    v_mfma_f32_32x32x16_bf16 v[88:103], v[128:131], v[132:135], v[88:103]
    ds_read_b64_tr_b16 v[194:195], v29 offset:5120
    ds_read_b128 v[196:199], v31
    v_mfma_f32_32x32x16_bf16 v[72:87], v[136:139], v[144:147], v[72:87]
    ds_read_b64_tr_b16 v[200:201], v28 offset:8192
    ds_read_b64_tr_b16 v[202:203], v28 offset:9216
    ds_read_b64_tr_b16 v[204:205], v29 offset:8192
    v_mfma_f32_32x32x16_bf16 v[88:103], v[140:143], v[144:147], v[88:103]
    ds_read_b64_tr_b16 v[206:207], v29 offset:9216
    ds_read_b128 v[208:211], v32
    v_mfma_f32_32x32x16_bf16 v[72:87], v[148:151], v[156:159], v[72:87]
    ds_read_b64_tr_b16 v[212:213], v28 offset:12288
    ds_read_b64_tr_b16 v[214:215], v28 offset:13312
    ds_read_b64_tr_b16 v[216:217], v29 offset:12288
    v_mfma_f32_32x32x16_bf16 v[88:103], v[152:155], v[156:159], v[88:103]
    ds_read_b64_tr_b16 v[218:219], v29 offset:13312
    ds_read_b128 v[220:223], v33
    v_add_u32 v28, 90112, v10
    v_add_u32 v29, 90112, v11
    v_add_u32 v30, 106496, v12
    v_xor_b32 v31, 32, v30
    v_xor_b32 v32, 64, v30
    v_xor_b32 v33, 96, v30
    s_waitcnt lgkmcnt(0)
    s_barrier
    v_mfma_f32_32x32x16_bf16 v[72:87], v[176:179], v[184:187], v[72:87]
    ds_read_b64_tr_b16 v[112:113], v28 offset:0
    ds_read_b64_tr_b16 v[114:115], v28 offset:1024
    ds_read_b64_tr_b16 v[116:117], v29 offset:0
    v_mfma_f32_32x32x16_bf16 v[88:103], v[180:183], v[184:187], v[88:103]
    ds_read_b64_tr_b16 v[118:119], v29 offset:1024
    ds_read_b128 v[120:123], v30
    v_mfma_f32_32x32x16_bf16 v[72:87], v[188:191], v[196:199], v[72:87]
    ds_read_b64_tr_b16 v[124:125], v28 offset:4096
    ds_read_b64_tr_b16 v[126:127], v28 offset:5120
    ds_read_b64_tr_b16 v[128:129], v29 offset:4096
    v_mfma_f32_32x32x16_bf16 v[88:103], v[192:195], v[196:199], v[88:103]
    ds_read_b64_tr_b16 v[130:131], v29 offset:5120
    ds_read_b128 v[132:135], v31
    v_mfma_f32_32x32x16_bf16 v[72:87], v[200:203], v[208:211], v[72:87]
    ds_read_b64_tr_b16 v[136:137], v28 offset:8192
    ds_read_b64_tr_b16 v[138:139], v28 offset:9216
    ds_read_b64_tr_b16 v[140:141], v29 offset:8192
    v_mfma_f32_32x32x16_bf16 v[88:103], v[204:207], v[208:211], v[88:103]
    ds_read_b64_tr_b16 v[142:143], v29 offset:9216
    ds_read_b128 v[144:147], v32
    v_mfma_f32_32x32x16_bf16 v[72:87], v[212:215], v[220:223], v[72:87]
    ds_read_b64_tr_b16 v[148:149], v28 offset:12288
    ds_read_b64_tr_b16 v[150:151], v28 offset:13312
    ds_read_b64_tr_b16 v[152:153], v29 offset:12288
    v_mfma_f32_32x32x16_bf16 v[88:103], v[216:219], v[220:223], v[88:103]
    ds_read_b64_tr_b16 v[154:155], v29 offset:13312
    ds_read_b128 v[156:159], v33
    v_add_u32 v28, 114688, v10
    v_add_u32 v29, 114688, v11
    v_add_u32 v30, 131072, v12
    v_xor_b32 v31, 32, v30
    v_xor_b32 v32, 64, v30
    v_xor_b32 v33, 96, v30
    s_waitcnt lgkmcnt(0)
    s_barrier
    v_mfma_f32_32x32x16_bf16 v[72:87], v[112:115], v[120:123], v[72:87]
    ds_read_b64_tr_b16 v[176:177], v28 offset:0
    ds_read_b64_tr_b16 v[178:179], v28 offset:1024
    ds_read_b64_tr_b16 v[180:181], v29 offset:0
    v_mfma_f32_32x32x16_bf16 v[88:103], v[116:119], v[120:123], v[88:103]
    ds_read_b64_tr_b16 v[182:183], v29 offset:1024
    ds_read_b128 v[184:187], v30
    v_mfma_f32_32x32x16_bf16 v[72:87], v[124:127], v[132:135], v[72:87]
    ds_read_b64_tr_b16 v[188:189], v28 offset:4096
    ds_read_b64_tr_b16 v[190:191], v28 offset:5120
    ds_read_b64_tr_b16 v[192:193], v29 offset:4096
    v_mfma_f32_32x32x16_bf16 v[88:103], v[128:131], v[132:135], v[88:103]
    ds_read_b64_tr_b16 v[194:195], v29 offset:5120
    ds_read_b128 v[196:199], v31
    v_mfma_f32_32x32x16_bf16 v[72:87], v[136:139], v[144:147], v[72:87]
    ds_read_b64_tr_b16 v[200:201], v28 offset:8192
    ds_read_b64_tr_b16 v[202:203], v28 offset:9216
    ds_read_b64_tr_b16 v[204:205], v29 offset:8192
    v_mfma_f32_32x32x16_bf16 v[88:103], v[140:143], v[144:147], v[88:103]
    ds_read_b64_tr_b16 v[206:207], v29 offset:9216
    ds_read_b128 v[208:211], v32
    v_mfma_f32_32x32x16_bf16 v[72:87], v[148:151], v[156:159], v[72:87]
    ds_read_b64_tr_b16 v[212:213], v28 offset:12288
    ds_read_b64_tr_b16 v[214:215], v28 offset:13312
    ds_read_b64_tr_b16 v[216:217], v29 offset:12288
    v_mfma_f32_32x32x16_bf16 v[88:103], v[152:155], v[156:159], v[88:103]
    ds_read_b64_tr_b16 v[218:219], v29 offset:13312
    ds_read_b128 v[220:223], v33
    v_add_u32 v28, 139264, v10
    v_add_u32 v29, 139264, v11
    v_add_u32 v30, 155648, v12
    v_xor_b32 v31, 32, v30
    v_xor_b32 v32, 64, v30
    v_xor_b32 v33, 96, v30
    s_waitcnt lgkmcnt(0)
    s_barrier
    v_mfma_f32_32x32x16_bf16 v[72:87], v[176:179], v[184:187], v[72:87]
    ds_read_b64_tr_b16 v[112:113], v28 offset:0
    ds_read_b64_tr_b16 v[114:115], v28 offset:1024
    ds_read_b64_tr_b16 v[116:117], v29 offset:0
    v_mfma_f32_32x32x16_bf16 v[88:103], v[180:183], v[184:187], v[88:103]
    ds_read_b64_tr_b16 v[118:119], v29 offset:1024
    ds_read_b128 v[120:123], v30
    v_mfma_f32_32x32x16_bf16 v[72:87], v[188:191], v[196:199], v[72:87]
    ds_read_b64_tr_b16 v[124:125], v28 offset:4096
    ds_read_b64_tr_b16 v[126:127], v28 offset:5120
    ds_read_b64_tr_b16 v[128:129], v29 offset:4096
    v_mfma_f32_32x32x16_bf16 v[88:103], v[192:195], v[196:199], v[88:103]
    ds_read_b64_tr_b16 v[130:131], v29 offset:5120
    ds_read_b128 v[132:135], v31
    v_mfma_f32_32x32x16_bf16 v[72:87], v[200:203], v[208:211], v[72:87]
    ds_read_b64_tr_b16 v[136:137], v28 offset:8192
    ds_read_b64_tr_b16 v[138:139], v28 offset:9216
    ds_read_b64_tr_b16 v[140:141], v29 offset:8192
    v_mfma_f32_32x32x16_bf16 v[88:103], v[204:207], v[208:211], v[88:103]
    ds_read_b64_tr_b16 v[142:143], v29 offset:9216
    ds_read_b128 v[144:147], v32
    v_mfma_f32_32x32x16_bf16 v[72:87], v[212:215], v[220:223], v[72:87]
    ds_read_b64_tr_b16 v[148:149], v28 offset:12288
    ds_read_b64_tr_b16 v[150:151], v28 offset:13312
    ds_read_b64_tr_b16 v[152:153], v29 offset:12288
    v_mfma_f32_32x32x16_bf16 v[88:103], v[216:219], v[220:223], v[88:103]
    ds_read_b64_tr_b16 v[154:155], v29 offset:13312
    ds_read_b128 v[156:159], v33
    s_waitcnt lgkmcnt(0)
    s_barrier
    v_mfma_f32_32x32x16_bf16 v[72:87], v[112:115], v[120:123], v[72:87]
    v_mfma_f32_32x32x16_bf16 v[88:103], v[116:119], v[120:123], v[88:103]
    v_mfma_f32_32x32x16_bf16 v[72:87], v[124:127], v[132:135], v[72:87]
    v_mfma_f32_32x32x16_bf16 v[88:103], v[128:131], v[132:135], v[88:103]
    v_mfma_f32_32x32x16_bf16 v[72:87], v[136:139], v[144:147], v[72:87]
    v_mfma_f32_32x32x16_bf16 v[88:103], v[140:143], v[144:147], v[88:103]
    v_mfma_f32_32x32x16_bf16 v[72:87], v[148:151], v[156:159], v[72:87]
    v_mfma_f32_32x32x16_bf16 v[88:103], v[152:155], v[156:159], v[88:103]
    s_lshl_b32 s49, s40, 13
    s_add_u32 s49, s49, 147456
    s_lshl_b32 s50, s41, 12
    s_add_u32 s50, s50, s49
    v_lshlrev_b32 v2, 4, v1
    v_add_u32 v3, s50, v2
    v_add_u32 v2, s49, v2
    v_mov_b32 v28, v13
    v_xor_b32 v29, 32, v13
    v_xor_b32 v30, 64, v13
    v_xor_b32 v31, 96, v13
    v_xor_b32 v32, 128, v13
    v_xor_b32 v33, 160, v13
    v_xor_b32 v34, 192, v13
    v_xor_b32 v35, 224, v13
    v_mov_b32 v176, 0
    v_mov_b32 v177, 0
    v_mov_b32 v178, 0
    v_mov_b32 v179, 0
    v_mov_b32 v180, 0
    v_mov_b32 v181, 0
    v_mov_b32 v182, 0
    v_mov_b32 v183, 0
    v_mov_b32 v184, 0
    v_mov_b32 v185, 0
    v_mov_b32 v186, 0
    v_mov_b32 v187, 0
    v_mov_b32 v188, 0
    v_mov_b32 v189, 0
    v_mov_b32 v190, 0
    v_mov_b32 v191, 0
    v_mov_b32 v192, 0
    v_mov_b32 v193, 0
    v_mov_b32 v194, 0
    v_mov_b32 v195, 0
    v_mov_b32 v196, 0
    v_mov_b32 v197, 0
    v_mov_b32 v198, 0
    v_mov_b32 v199, 0
    v_mov_b32 v200, 0
    v_mov_b32 v201, 0
    v_mov_b32 v202, 0
    v_mov_b32 v203, 0
    v_mov_b32 v204, 0
    v_mov_b32 v205, 0
    v_mov_b32 v206, 0
    v_mov_b32 v207, 0
    v_mov_b32 v208, 0
    v_mov_b32 v209, 0
    v_mov_b32 v210, 0
    v_mov_b32 v211, 0
    v_mov_b32 v212, 0
    v_mov_b32 v213, 0
    v_mov_b32 v214, 0
    v_mov_b32 v215, 0
    v_mov_b32 v216, 0
    v_mov_b32 v217, 0
    v_mov_b32 v218, 0
    v_mov_b32 v219, 0
    v_mov_b32 v220, 0
    v_mov_b32 v221, 0
    v_mov_b32 v222, 0
    v_mov_b32 v223, 0
    v_mov_b32 v224, 0
    v_mov_b32 v225, 0
    v_mov_b32 v226, 0
    v_mov_b32 v227, 0
    v_mov_b32 v228, 0
    v_mov_b32 v229, 0
    v_mov_b32 v230, 0
    v_mov_b32 v231, 0
    v_mov_b32 v232, 0
    v_mov_b32 v233, 0
    v_mov_b32 v234, 0
    v_mov_b32 v235, 0
    v_mov_b32 v236, 0
    v_mov_b32 v237, 0
    v_mov_b32 v238, 0
    v_mov_b32 v239, 0
    v_cvt_pk_bf16_f32 v144, v72, v73
    v_cvt_pk_bf16_f32 v145, v74, v75
    v_cvt_pk_bf16_f32 v146, v76, v77
    v_cvt_pk_bf16_f32 v147, v78, v79
    v_cvt_pk_bf16_f32 v148, v80, v81
    v_cvt_pk_bf16_f32 v149, v82, v83
    v_cvt_pk_bf16_f32 v150, v84, v85
    v_cvt_pk_bf16_f32 v151, v86, v87
    v_cvt_pk_bf16_f32 v152, v88, v89
    v_cvt_pk_bf16_f32 v153, v90, v91
    v_cvt_pk_bf16_f32 v154, v92, v93
    v_cvt_pk_bf16_f32 v155, v94, v95
    v_cvt_pk_bf16_f32 v156, v96, v97
    v_cvt_pk_bf16_f32 v157, v98, v99
    v_cvt_pk_bf16_f32 v158, v100, v101
    v_cvt_pk_bf16_f32 v159, v102, v103
    ds_write_b128 v3, v[144:147] offset:0
    ds_write_b128 v3, v[148:151] offset:1024
    ds_write_b128 v3, v[152:155] offset:2048
    ds_write_b128 v3, v[156:159] offset:3072
    s_waitcnt lgkmcnt(0)
    s_barrier
    ds_read_b128 v[40:43], v2 offset:0
    ds_read_b128 v[44:47], v2 offset:1024
    ds_read_b128 v[48:51], v2 offset:2048
    ds_read_b128 v[52:55], v2 offset:3072
    ds_read_b128 v[56:59], v2 offset:4096
    ds_read_b128 v[60:63], v2 offset:5120
    ds_read_b128 v[64:67], v2 offset:6144
    ds_read_b128 v[68:71], v2 offset:7168
    s_waitcnt lgkmcnt(0)
    s_barrier
    ds_read_b128 v[112:115], v28
    ds_read_b128 v[116:119], v29
    ds_read_b128 v[120:123], v30
    ds_read_b128 v[124:127], v31
    ds_read_b128 v[128:131], v32
    ds_read_b128 v[132:135], v33
    ds_read_b128 v[136:139], v34
    ds_read_b128 v[140:143], v35
    s_mov_b32 s42, 16384
    v_add_u32 v28, s42, v13
    v_xor_b32 v29, 32, v28
    v_xor_b32 v30, 64, v28
    v_xor_b32 v31, 96, v28
    v_xor_b32 v32, 128, v28
    v_xor_b32 v33, 160, v28
    v_xor_b32 v34, 192, v28
    v_xor_b32 v35, 224, v28
    s_waitcnt lgkmcnt(0)
    s_barrier
    v_mfma_f32_32x32x16_bf16 v[72:87], v[112:115], v[40:43], 0
    v_mfma_f32_32x32x16_bf16 v[72:87], v[116:119], v[44:47], v[72:87]
    v_mfma_f32_32x32x16_bf16 v[72:87], v[120:123], v[48:51], v[72:87]
    v_mfma_f32_32x32x16_bf16 v[72:87], v[124:127], v[52:55], v[72:87]
    v_mfma_f32_32x32x16_bf16 v[72:87], v[128:131], v[56:59], v[72:87]
    v_mfma_f32_32x32x16_bf16 v[72:87], v[132:135], v[60:63], v[72:87]
    v_mfma_f32_32x32x16_bf16 v[72:87], v[136:139], v[64:67], v[72:87]
    v_mfma_f32_32x32x16_bf16 v[72:87], v[140:143], v[68:71], v[72:87]
    ds_read_b128 v[112:115], v28
    ds_read_b128 v[116:119], v29
    ds_read_b128 v[120:123], v30
    ds_read_b128 v[124:127], v31
    ds_read_b128 v[128:131], v32
    ds_read_b128 v[132:135], v33
    ds_read_b128 v[136:139], v34
    ds_read_b128 v[140:143], v35
    s_mov_b32 s43, 32768
    s_mov_b32 s42, 49152
    s_mov_b32 s46, 0
    v_add_u32 v14, s43, v24
    v_add_u32 v15, s43, v25
    v_add_u32 v16, s43, v26
    v_add_u32 v17, s43, v27
    v_add_u32 v28, s42, v13
    v_xor_b32 v29, 32, v28
    v_xor_b32 v30, 64, v28
    v_xor_b32 v31, 96, v28
    v_xor_b32 v32, 128, v28
    v_xor_b32 v33, 160, v28
    v_xor_b32 v34, 192, v28
    v_xor_b32 v35, 224, v28
    v_max3_f32 v2, v72, v73, v74
    v_max3_f32 v3, v75, v76, v77
    v_max3_f32 v2, v2, v78, v79
    v_max3_f32 v3, v3, v80, v81
    v_max3_f32 v2, v2, v82, v83
    v_max3_f32 v3, v3, v84, v85
    v_max3_f32 v2, v2, v86, v87
    v_max_f32 v2, v2, v3
    v_mov_b32 v3, v2
    s_nop 1
    v_permlane32_swap_b32 v2, v3
    v_max_f32 v2, v2, v3
    v_mul_f32 v18, s48, v2
K1_LOOP:
    s_waitcnt lgkmcnt(0)
    s_barrier
    v_cmp_gt_f32 vcc, v18, v37
    s_cbranch_vccnz K1_RSL0
K1_BKL0:
    v_mfma_f32_32x32x16_bf16 v[88:103], v[112:115], v[40:43], 0
    ds_read_b64_tr_b16 v[144:145], v14 offset:0
    ds_read_b64_tr_b16 v[146:147], v14 offset:2048
    v_fma_f32 v72, v72, s48, -v36
    v_fma_f32 v73, v73, s48, -v36
    v_exp_f32 v72, v72
    v_exp_f32 v73, v73
    v_mfma_f32_32x32x16_bf16 v[88:103], v[116:119], v[44:47], v[88:103]
    ds_read_b64_tr_b16 v[148:149], v14 offset:4096
    ds_read_b64_tr_b16 v[150:151], v14 offset:6144
    v_fma_f32 v74, v74, s48, -v36
    v_fma_f32 v75, v75, s48, -v36
    v_exp_f32 v74, v74
    v_exp_f32 v75, v75
    v_cvt_pk_bf16_f32 v104, v72, v73
    v_add_f32 v38, v38, v72
    v_add_f32 v39, v39, v73
    v_mfma_f32_32x32x16_bf16 v[88:103], v[120:123], v[48:51], v[88:103]
    ds_read_b64_tr_b16 v[152:153], v15 offset:0
    ds_read_b64_tr_b16 v[154:155], v15 offset:2048
    v_fma_f32 v76, v76, s48, -v36
    v_fma_f32 v77, v77, s48, -v36
    v_exp_f32 v76, v76
    v_exp_f32 v77, v77
    v_cvt_pk_bf16_f32 v105, v74, v75
    v_add_f32 v38, v38, v74
    v_add_f32 v39, v39, v75
    v_mfma_f32_32x32x16_bf16 v[88:103], v[124:127], v[52:55], v[88:103]
    ds_read_b64_tr_b16 v[156:157], v15 offset:4096
    ds_read_b64_tr_b16 v[158:159], v15 offset:6144
    v_fma_f32 v78, v78, s48, -v36
    v_fma_f32 v79, v79, s48, -v36
    v_exp_f32 v78, v78
    v_exp_f32 v79, v79
    v_cvt_pk_bf16_f32 v106, v76, v77
    v_add_f32 v38, v38, v76
    v_add_f32 v39, v39, v77
    v_mfma_f32_32x32x16_bf16 v[88:103], v[128:131], v[56:59], v[88:103]
    ds_read_b64_tr_b16 v[160:161], v16 offset:0
    ds_read_b64_tr_b16 v[162:163], v16 offset:2048
    v_fma_f32 v80, v80, s48, -v36
    v_fma_f32 v81, v81, s48, -v36
    v_exp_f32 v80, v80
    v_exp_f32 v81, v81
    v_cvt_pk_bf16_f32 v107, v78, v79
    v_add_f32 v38, v38, v78
    v_add_f32 v39, v39, v79
    v_mfma_f32_32x32x16_bf16 v[88:103], v[132:135], v[60:63], v[88:103]
    ds_read_b64_tr_b16 v[164:165], v16 offset:4096
    ds_read_b64_tr_b16 v[166:167], v16 offset:6144
    v_fma_f32 v82, v82, s48, -v36
    v_fma_f32 v83, v83, s48, -v36
    v_exp_f32 v82, v82
    v_exp_f32 v83, v83
    v_cvt_pk_bf16_f32 v108, v80, v81
    v_add_f32 v38, v38, v80
    v_add_f32 v39, v39, v81
    v_mfma_f32_32x32x16_bf16 v[88:103], v[136:139], v[64:67], v[88:103]
    ds_read_b64_tr_b16 v[168:169], v17 offset:0
    ds_read_b64_tr_b16 v[170:171], v17 offset:2048
    v_fma_f32 v84, v84, s48, -v36
    v_fma_f32 v85, v85, s48, -v36
    v_exp_f32 v84, v84
    v_exp_f32 v85, v85
    v_cvt_pk_bf16_f32 v109, v82, v83
    v_add_f32 v38, v38, v82
    v_add_f32 v39, v39, v83
    v_mfma_f32_32x32x16_bf16 v[88:103], v[140:143], v[68:71], v[88:103]
    ds_read_b64_tr_b16 v[172:173], v17 offset:4096
    ds_read_b64_tr_b16 v[174:175], v17 offset:6144
    v_fma_f32 v86, v86, s48, -v36
    v_fma_f32 v87, v87, s48, -v36
    v_exp_f32 v86, v86
    v_exp_f32 v87, v87
    v_cvt_pk_bf16_f32 v110, v84, v85
    v_add_f32 v38, v38, v84
    v_add_f32 v39, v39, v85
    v_cvt_pk_bf16_f32 v111, v86, v87
    v_add_f32 v38, v38, v86
    v_add_f32 v39, v39, v87
    s_waitcnt lgkmcnt(0)
    s_barrier
    v_mfma_f32_32x32x16_bf16 v[176:191], v[144:147], v[104:107], v[176:191]
    ds_read_b128 v[112:115], v28
    s_add_u32 s43, s43, 32768
    s_cmp_ge_u32 s43, 163840
    s_cselect_b32 s49, 163840, 0
    s_sub_u32 s43, s43, s49
    s_add_u32 s42, s42, 32768
    s_cmp_ge_u32 s42, 163840
    s_cselect_b32 s49, 163840, 0
    s_sub_u32 s42, s42, s49
    v_mfma_f32_32x32x16_bf16 v[176:191], v[148:151], v[108:111], v[176:191]
    ds_read_b128 v[116:119], v29
    v_max3_f32 v2, v88, v89, v90
    v_max3_f32 v3, v91, v92, v93
    v_max3_f32 v2, v2, v94, v95
    v_max3_f32 v3, v3, v96, v97
    v_max3_f32 v2, v2, v98, v99
    v_max3_f32 v3, v3, v100, v101
    v_max3_f32 v2, v2, v102, v103
    v_max_f32 v2, v2, v3
    v_mov_b32 v3, v2
    s_nop 1
    v_permlane32_swap_b32 v2, v3
    v_max_f32 v2, v2, v3
    v_mul_f32 v18, s48, v2
    v_mfma_f32_32x32x16_bf16 v[192:207], v[152:155], v[104:107], v[192:207]
    ds_read_b128 v[120:123], v30
    v_mfma_f32_32x32x16_bf16 v[192:207], v[156:159], v[108:111], v[192:207]
    ds_read_b128 v[124:127], v31
    v_add_u32 v14, s43, v24
    v_add_u32 v15, s43, v25
    v_add_u32 v16, s43, v26
    v_add_u32 v17, s43, v27
    v_mfma_f32_32x32x16_bf16 v[208:223], v[160:163], v[104:107], v[208:223]
    ds_read_b128 v[128:131], v32
    v_mfma_f32_32x32x16_bf16 v[208:223], v[164:167], v[108:111], v[208:223]
    ds_read_b128 v[132:135], v33
    v_mfma_f32_32x32x16_bf16 v[224:239], v[168:171], v[104:107], v[224:239]
    ds_read_b128 v[136:139], v34
    v_mfma_f32_32x32x16_bf16 v[224:239], v[172:175], v[108:111], v[224:239]
    ds_read_b128 v[140:143], v35
    v_add_u32 v28, s42, v13
    v_xor_b32 v29, 32, v28
    v_xor_b32 v30, 64, v28
    v_xor_b32 v31, 96, v28
    v_xor_b32 v32, 128, v28
    v_xor_b32 v33, 160, v28
    v_xor_b32 v34, 192, v28
    v_xor_b32 v35, 224, v28
    s_waitcnt lgkmcnt(0)
    s_barrier
    v_cmp_gt_f32 vcc, v18, v37
    s_cbranch_vccnz K1_RSL1
K1_BKL1:
    v_mfma_f32_32x32x16_bf16 v[72:87], v[112:115], v[40:43], 0
    ds_read_b64_tr_b16 v[144:145], v14 offset:0
    ds_read_b64_tr_b16 v[146:147], v14 offset:2048
    v_fma_f32 v88, v88, s48, -v36
    v_fma_f32 v89, v89, s48, -v36
    v_exp_f32 v88, v88
    v_exp_f32 v89, v89
    v_mfma_f32_32x32x16_bf16 v[72:87], v[116:119], v[44:47], v[72:87]
    ds_read_b64_tr_b16 v[148:149], v14 offset:4096
    ds_read_b64_tr_b16 v[150:151], v14 offset:6144
    v_fma_f32 v90, v90, s48, -v36
    v_fma_f32 v91, v91, s48, -v36
    v_exp_f32 v90, v90
    v_exp_f32 v91, v91
    v_cvt_pk_bf16_f32 v104, v88, v89
    v_add_f32 v38, v38, v88
    v_add_f32 v39, v39, v89
    v_mfma_f32_32x32x16_bf16 v[72:87], v[120:123], v[48:51], v[72:87]
    ds_read_b64_tr_b16 v[152:153], v15 offset:0
    ds_read_b64_tr_b16 v[154:155], v15 offset:2048
    v_fma_f32 v92, v92, s48, -v36
    v_fma_f32 v93, v93, s48, -v36
    v_exp_f32 v92, v92
    v_exp_f32 v93, v93
    v_cvt_pk_bf16_f32 v105, v90, v91
    v_add_f32 v38, v38, v90
    v_add_f32 v39, v39, v91
    v_mfma_f32_32x32x16_bf16 v[72:87], v[124:127], v[52:55], v[72:87]
    ds_read_b64_tr_b16 v[156:157], v15 offset:4096
    ds_read_b64_tr_b16 v[158:159], v15 offset:6144
    v_fma_f32 v94, v94, s48, -v36
    v_fma_f32 v95, v95, s48, -v36
    v_exp_f32 v94, v94
    v_exp_f32 v95, v95
    v_cvt_pk_bf16_f32 v106, v92, v93
    v_add_f32 v38, v38, v92
    v_add_f32 v39, v39, v93
    v_mfma_f32_32x32x16_bf16 v[72:87], v[128:131], v[56:59], v[72:87]
    ds_read_b64_tr_b16 v[160:161], v16 offset:0
    ds_read_b64_tr_b16 v[162:163], v16 offset:2048
    v_fma_f32 v96, v96, s48, -v36
    v_fma_f32 v97, v97, s48, -v36
    v_exp_f32 v96, v96
    v_exp_f32 v97, v97
    v_cvt_pk_bf16_f32 v107, v94, v95
    v_add_f32 v38, v38, v94
    v_add_f32 v39, v39, v95
    v_mfma_f32_32x32x16_bf16 v[72:87], v[132:135], v[60:63], v[72:87]
    ds_read_b64_tr_b16 v[164:165], v16 offset:4096
    ds_read_b64_tr_b16 v[166:167], v16 offset:6144
    v_fma_f32 v98, v98, s48, -v36
    v_fma_f32 v99, v99, s48, -v36
    v_exp_f32 v98, v98
    v_exp_f32 v99, v99
    v_cvt_pk_bf16_f32 v108, v96, v97
    v_add_f32 v38, v38, v96
    v_add_f32 v39, v39, v97
    v_mfma_f32_32x32x16_bf16 v[72:87], v[136:139], v[64:67], v[72:87]
    ds_read_b64_tr_b16 v[168:169], v17 offset:0
    ds_read_b64_tr_b16 v[170:171], v17 offset:2048
    v_fma_f32 v100, v100, s48, -v36
    v_fma_f32 v101, v101, s48, -v36
    v_exp_f32 v100, v100
    v_exp_f32 v101, v101
    v_cvt_pk_bf16_f32 v109, v98, v99
    v_add_f32 v38, v38, v98
    v_add_f32 v39, v39, v99
    v_mfma_f32_32x32x16_bf16 v[72:87], v[140:143], v[68:71], v[72:87]
    ds_read_b64_tr_b16 v[172:173], v17 offset:4096
    ds_read_b64_tr_b16 v[174:175], v17 offset:6144
    v_fma_f32 v102, v102, s48, -v36
    v_fma_f32 v103, v103, s48, -v36
    v_exp_f32 v102, v102
    v_exp_f32 v103, v103
    v_cvt_pk_bf16_f32 v110, v100, v101
    v_add_f32 v38, v38, v100
    v_add_f32 v39, v39, v101
    v_cvt_pk_bf16_f32 v111, v102, v103
    v_add_f32 v38, v38, v102
    v_add_f32 v39, v39, v103
    s_waitcnt lgkmcnt(0)
    s_barrier
    v_mfma_f32_32x32x16_bf16 v[176:191], v[144:147], v[104:107], v[176:191]
    ds_read_b128 v[112:115], v28
    s_add_u32 s43, s43, 32768
    s_cmp_ge_u32 s43, 163840
    s_cselect_b32 s49, 163840, 0
    s_sub_u32 s43, s43, s49
    s_add_u32 s42, s42, 32768
    s_cmp_ge_u32 s42, 163840
    s_cselect_b32 s49, 163840, 0
    s_sub_u32 s42, s42, s49
    v_mfma_f32_32x32x16_bf16 v[176:191], v[148:151], v[108:111], v[176:191]
    ds_read_b128 v[116:119], v29
    v_max3_f32 v2, v72, v73, v74
    v_max3_f32 v3, v75, v76, v77
    v_max3_f32 v2, v2, v78, v79
    v_max3_f32 v3, v3, v80, v81
    v_max3_f32 v2, v2, v82, v83
    v_max3_f32 v3, v3, v84, v85
    v_max3_f32 v2, v2, v86, v87
    v_max_f32 v2, v2, v3
    v_mov_b32 v3, v2
    s_nop 1
    v_permlane32_swap_b32 v2, v3
    v_max_f32 v2, v2, v3
    v_mul_f32 v18, s48, v2
    v_mfma_f32_32x32x16_bf16 v[192:207], v[152:155], v[104:107], v[192:207]
    ds_read_b128 v[120:123], v30
    v_mfma_f32_32x32x16_bf16 v[192:207], v[156:159], v[108:111], v[192:207]
    ds_read_b128 v[124:127], v31
    v_add_u32 v14, s43, v24
    v_add_u32 v15, s43, v25
    v_add_u32 v16, s43, v26
    v_add_u32 v17, s43, v27
    v_mfma_f32_32x32x16_bf16 v[208:223], v[160:163], v[104:107], v[208:223]
    ds_read_b128 v[128:131], v32
    v_mfma_f32_32x32x16_bf16 v[208:223], v[164:167], v[108:111], v[208:223]
    ds_read_b128 v[132:135], v33
    v_mfma_f32_32x32x16_bf16 v[224:239], v[168:171], v[104:107], v[224:239]
    ds_read_b128 v[136:139], v34
    v_mfma_f32_32x32x16_bf16 v[224:239], v[172:175], v[108:111], v[224:239]
    ds_read_b128 v[140:143], v35
    v_add_u32 v28, s42, v13
    v_xor_b32 v29, 32, v28
    v_xor_b32 v30, 64, v28
    v_xor_b32 v31, 96, v28
    v_xor_b32 v32, 128, v28
    v_xor_b32 v33, 160, v28
    v_xor_b32 v34, 192, v28
    v_xor_b32 v35, 224, v28
    s_add_u32 s46, s46, 1
    s_cmp_lt_u32 s46, 7
    s_cbranch_scc1 K1_LOOP
    s_waitcnt lgkmcnt(0)
    s_barrier
    v_cmp_gt_f32 vcc, v18, v37
    s_cbranch_vccnz K1_RSA
K1_BKA:
    v_mfma_f32_32x32x16_bf16 v[88:103], v[112:115], v[40:43], 0
    ds_read_b64_tr_b16 v[144:145], v14 offset:0
    ds_read_b64_tr_b16 v[146:147], v14 offset:2048
    v_fma_f32 v72, v72, s48, -v36
    v_fma_f32 v73, v73, s48, -v36
    v_exp_f32 v72, v72
    v_exp_f32 v73, v73
    v_mfma_f32_32x32x16_bf16 v[88:103], v[116:119], v[44:47], v[88:103]
    ds_read_b64_tr_b16 v[148:149], v14 offset:4096
    ds_read_b64_tr_b16 v[150:151], v14 offset:6144
    v_fma_f32 v74, v74, s48, -v36
    v_fma_f32 v75, v75, s48, -v36
    v_exp_f32 v74, v74
    v_exp_f32 v75, v75
    v_cvt_pk_bf16_f32 v104, v72, v73
    v_add_f32 v38, v38, v72
    v_add_f32 v39, v39, v73
    v_mfma_f32_32x32x16_bf16 v[88:103], v[120:123], v[48:51], v[88:103]
    ds_read_b64_tr_b16 v[152:153], v15 offset:0
    ds_read_b64_tr_b16 v[154:155], v15 offset:2048
    v_fma_f32 v76, v76, s48, -v36
    v_fma_f32 v77, v77, s48, -v36
    v_exp_f32 v76, v76
    v_exp_f32 v77, v77
    v_cvt_pk_bf16_f32 v105, v74, v75
    v_add_f32 v38, v38, v74
    v_add_f32 v39, v39, v75
    v_mfma_f32_32x32x16_bf16 v[88:103], v[124:127], v[52:55], v[88:103]
    ds_read_b64_tr_b16 v[156:157], v15 offset:4096
    ds_read_b64_tr_b16 v[158:159], v15 offset:6144
    v_fma_f32 v78, v78, s48, -v36
    v_fma_f32 v79, v79, s48, -v36
    v_exp_f32 v78, v78
    v_exp_f32 v79, v79
    v_cvt_pk_bf16_f32 v106, v76, v77
    v_add_f32 v38, v38, v76
    v_add_f32 v39, v39, v77
    v_mfma_f32_32x32x16_bf16 v[88:103], v[128:131], v[56:59], v[88:103]
    ds_read_b64_tr_b16 v[160:161], v16 offset:0
    ds_read_b64_tr_b16 v[162:163], v16 offset:2048
    v_fma_f32 v80, v80, s48, -v36
    v_fma_f32 v81, v81, s48, -v36
    v_exp_f32 v80, v80
    v_exp_f32 v81, v81
    v_cvt_pk_bf16_f32 v107, v78, v79
    v_add_f32 v38, v38, v78
    v_add_f32 v39, v39, v79
    v_mfma_f32_32x32x16_bf16 v[88:103], v[132:135], v[60:63], v[88:103]
    ds_read_b64_tr_b16 v[164:165], v16 offset:4096
    ds_read_b64_tr_b16 v[166:167], v16 offset:6144
    v_fma_f32 v82, v82, s48, -v36
    v_fma_f32 v83, v83, s48, -v36
    v_exp_f32 v82, v82
    v_exp_f32 v83, v83
    v_cvt_pk_bf16_f32 v108, v80, v81
    v_add_f32 v38, v38, v80
    v_add_f32 v39, v39, v81
    v_mfma_f32_32x32x16_bf16 v[88:103], v[136:139], v[64:67], v[88:103]
    ds_read_b64_tr_b16 v[168:169], v17 offset:0
    ds_read_b64_tr_b16 v[170:171], v17 offset:2048
    v_fma_f32 v84, v84, s48, -v36
    v_fma_f32 v85, v85, s48, -v36
    v_exp_f32 v84, v84
    v_exp_f32 v85, v85
    v_cvt_pk_bf16_f32 v109, v82, v83
    v_add_f32 v38, v38, v82
    v_add_f32 v39, v39, v83
    v_mfma_f32_32x32x16_bf16 v[88:103], v[140:143], v[68:71], v[88:103]
    ds_read_b64_tr_b16 v[172:173], v17 offset:4096
    ds_read_b64_tr_b16 v[174:175], v17 offset:6144
    v_fma_f32 v86, v86, s48, -v36
    v_fma_f32 v87, v87, s48, -v36
    v_exp_f32 v86, v86
    v_exp_f32 v87, v87
    v_cvt_pk_bf16_f32 v110, v84, v85
    v_add_f32 v38, v38, v84
    v_add_f32 v39, v39, v85
    v_cvt_pk_bf16_f32 v111, v86, v87
    v_add_f32 v38, v38, v86
    v_add_f32 v39, v39, v87
    s_waitcnt lgkmcnt(0)
    v_mfma_f32_32x32x16_bf16 v[176:191], v[144:147], v[104:107], v[176:191]
    s_add_u32 s43, s43, 32768
    s_cmp_ge_u32 s43, 163840
    s_cselect_b32 s49, 163840, 0
    s_sub_u32 s43, s43, s49
    s_add_u32 s42, s42, 32768
    s_cmp_ge_u32 s42, 163840
    s_cselect_b32 s49, 163840, 0
    s_sub_u32 s42, s42, s49
    v_mfma_f32_32x32x16_bf16 v[176:191], v[148:151], v[108:111], v[176:191]
    v_max3_f32 v2, v88, v89, v90
    v_max3_f32 v3, v91, v92, v93
    v_max3_f32 v2, v2, v94, v95
    v_max3_f32 v3, v3, v96, v97
    v_max3_f32 v2, v2, v98, v99
    v_max3_f32 v3, v3, v100, v101
    v_max3_f32 v2, v2, v102, v103
    v_max_f32 v2, v2, v3
    v_mov_b32 v3, v2
    s_nop 1
    v_permlane32_swap_b32 v2, v3
    v_max_f32 v2, v2, v3
    v_mul_f32 v18, s48, v2
    v_mfma_f32_32x32x16_bf16 v[192:207], v[152:155], v[104:107], v[192:207]
    v_mfma_f32_32x32x16_bf16 v[192:207], v[156:159], v[108:111], v[192:207]
    v_add_u32 v14, s43, v24
    v_add_u32 v15, s43, v25
    v_add_u32 v16, s43, v26
    v_add_u32 v17, s43, v27
    v_mfma_f32_32x32x16_bf16 v[208:223], v[160:163], v[104:107], v[208:223]
    v_mfma_f32_32x32x16_bf16 v[208:223], v[164:167], v[108:111], v[208:223]
    v_mfma_f32_32x32x16_bf16 v[224:239], v[168:171], v[104:107], v[224:239]
    v_mfma_f32_32x32x16_bf16 v[224:239], v[172:175], v[108:111], v[224:239]
    v_add_u32 v28, s42, v13
    v_xor_b32 v29, 32, v28
    v_xor_b32 v30, 64, v28
    v_xor_b32 v31, 96, v28
    v_xor_b32 v32, 128, v28
    v_xor_b32 v33, 160, v28
    v_xor_b32 v34, 192, v28
    v_xor_b32 v35, 224, v28
    s_waitcnt lgkmcnt(0)
    s_barrier
    v_cmp_gt_f32 vcc, v18, v37
    s_cbranch_vccnz K1_RSB
K1_BKB:
    ds_read_b64_tr_b16 v[144:145], v14 offset:0
    ds_read_b64_tr_b16 v[146:147], v14 offset:2048
    v_fma_f32 v88, v88, s48, -v36
    v_fma_f32 v89, v89, s48, -v36
    v_exp_f32 v88, v88
    v_exp_f32 v89, v89
    ds_read_b64_tr_b16 v[148:149], v14 offset:4096
    ds_read_b64_tr_b16 v[150:151], v14 offset:6144
    v_fma_f32 v90, v90, s48, -v36
    v_fma_f32 v91, v91, s48, -v36
    v_exp_f32 v90, v90
    v_exp_f32 v91, v91
    v_cvt_pk_bf16_f32 v104, v88, v89
    v_add_f32 v38, v38, v88
    v_add_f32 v39, v39, v89
    ds_read_b64_tr_b16 v[152:153], v15 offset:0
    ds_read_b64_tr_b16 v[154:155], v15 offset:2048
    v_fma_f32 v92, v92, s48, -v36
    v_fma_f32 v93, v93, s48, -v36
    v_exp_f32 v92, v92
    v_exp_f32 v93, v93
    v_cvt_pk_bf16_f32 v105, v90, v91
    v_add_f32 v38, v38, v90
    v_add_f32 v39, v39, v91
    ds_read_b64_tr_b16 v[156:157], v15 offset:4096
    ds_read_b64_tr_b16 v[158:159], v15 offset:6144
    v_fma_f32 v94, v94, s48, -v36
    v_fma_f32 v95, v95, s48, -v36
    v_exp_f32 v94, v94
    v_exp_f32 v95, v95
    v_cvt_pk_bf16_f32 v106, v92, v93
    v_add_f32 v38, v38, v92
    v_add_f32 v39, v39, v93
    ds_read_b64_tr_b16 v[160:161], v16 offset:0
    ds_read_b64_tr_b16 v[162:163], v16 offset:2048
    v_fma_f32 v96, v96, s48, -v36
    v_fma_f32 v97, v97, s48, -v36
    v_exp_f32 v96, v96
    v_exp_f32 v97, v97
    v_cvt_pk_bf16_f32 v107, v94, v95
    v_add_f32 v38, v38, v94
    v_add_f32 v39, v39, v95
    ds_read_b64_tr_b16 v[164:165], v16 offset:4096
    ds_read_b64_tr_b16 v[166:167], v16 offset:6144
    v_fma_f32 v98, v98, s48, -v36
    v_fma_f32 v99, v99, s48, -v36
    v_exp_f32 v98, v98
    v_exp_f32 v99, v99
    v_cvt_pk_bf16_f32 v108, v96, v97
    v_add_f32 v38, v38, v96
    v_add_f32 v39, v39, v97
    ds_read_b64_tr_b16 v[168:169], v17 offset:0
    ds_read_b64_tr_b16 v[170:171], v17 offset:2048
    v_fma_f32 v100, v100, s48, -v36
    v_fma_f32 v101, v101, s48, -v36
    v_exp_f32 v100, v100
    v_exp_f32 v101, v101
    v_cvt_pk_bf16_f32 v109, v98, v99
    v_add_f32 v38, v38, v98
    v_add_f32 v39, v39, v99
    ds_read_b64_tr_b16 v[172:173], v17 offset:4096
    ds_read_b64_tr_b16 v[174:175], v17 offset:6144
    v_fma_f32 v102, v102, s48, -v36
    v_fma_f32 v103, v103, s48, -v36
    v_exp_f32 v102, v102
    v_exp_f32 v103, v103
    v_cvt_pk_bf16_f32 v110, v100, v101
    v_add_f32 v38, v38, v100
    v_add_f32 v39, v39, v101
    v_cvt_pk_bf16_f32 v111, v102, v103
    v_add_f32 v38, v38, v102
    v_add_f32 v39, v39, v103
    s_waitcnt lgkmcnt(0)
    v_mfma_f32_32x32x16_bf16 v[208:223], v[160:163], v[104:107], v[208:223]
    v_mfma_f32_32x32x16_bf16 v[208:223], v[164:167], v[108:111], v[208:223]
    v_mfma_f32_32x32x16_bf16 v[224:239], v[168:171], v[104:107], v[224:239]
    v_mfma_f32_32x32x16_bf16 v[224:239], v[172:175], v[108:111], v[224:239]
    v_mfma_f32_32x32x16_bf16 v[176:191], v[144:147], v[104:107], v[176:191]
    v_mfma_f32_32x32x16_bf16 v[176:191], v[148:151], v[108:111], v[176:191]
    v_mfma_f32_32x32x16_bf16 v[192:207], v[152:155], v[104:107], v[192:207]
    v_mfma_f32_32x32x16_bf16 v[192:207], v[156:159], v[108:111], v[192:207]
    v_add_f32 v38, v38, v39
    v_mov_b32 v39, v38
    s_nop 1
    v_permlane32_swap_b32 v38, v39
    v_add_f32 v37, v38, v39
    v_and_b32 v7, 31, v1
    v_lshlrev_b32 v7, 3, v7
    s_lshl_b32 s49, s36, 8
    s_add_u32 s49, s49, 36864
    s_xor_b32 s50, s36, 2
    s_lshl_b32 s50, s50, 8
    s_add_u32 s50, s50, 36864
    v_add_u32 v2, s49, v7
    v_add_u32 v7, s50, v7
    v_lshlrev_b32 v3, 4, v1
    s_xor_b32 s50, s36, 2
    s_lshl_b32 s50, s50, 13
    s_add_u32 s50, s50, 0
    s_lshl_b32 s49, s36, 13
    s_add_u32 s49, s49, 0
    v_add_u32 v4, s50, v3
    v_add_u32 v5, s49, v3
    s_mov_b32 s32, s12
    s_mov_b32 s33, s13
    s_mov_b32 s34, 17825792
    s_mov_b32 s35, 0x20000
    s_mul_i32 s49, s39, 589824
    s_mul_i32 s50, s47, 288
    s_add_u32 s49, s49, s50
    s_add_u32 s24, s14, s49
    s_addc_u32 s25, s15, 0
    s_sub_u32 s26, 4718592, s49
    s_mov_b32 s27, 0x20000
    s_barrier
    ds_write_b64 v2, v[36:37]
    ds_write_b128 v4, v[208:211] offset:0
    ds_write_b128 v4, v[212:215] offset:1024
    ds_write_b128 v4, v[216:219] offset:2048
    ds_write_b128 v4, v[220:223] offset:3072
    ds_write_b128 v4, v[224:227] offset:4096
    ds_write_b128 v4, v[228:231] offset:5120
    ds_write_b128 v4, v[232:235] offset:6144
    ds_write_b128 v4, v[236:239] offset:7168
    s_waitcnt lgkmcnt(0)
    s_barrier
    ds_read_b64 v[72:73], v7
    ds_read_b128 v[208:211], v5 offset:0
    ds_read_b128 v[212:215], v5 offset:1024
    ds_read_b128 v[216:219], v5 offset:2048
    ds_read_b128 v[220:223], v5 offset:3072
    ds_read_b128 v[224:227], v5 offset:4096
    ds_read_b128 v[228:231], v5 offset:5120
    ds_read_b128 v[232:235], v5 offset:6144
    ds_read_b128 v[236:239], v5 offset:7168
    v_mov_b32 v6, 38912
    ds_read_b64 v[8:9], v6
    s_waitcnt lgkmcnt(9)
    v_max_f32 v2, v36, v72
    v_sub_f32 v3, v36, v2
    v_sub_f32 v4, v72, v2
    v_exp_f32 v3, v3
    v_exp_f32 v4, v4
    v_mul_f32 v5, v3, v37
    v_fmac_f32 v5, v4, v73
    v_rcp_f32 v6, v5
    s_nop 0
    v_mul_f32 v3, v3, v6
    v_mul_f32 v4, v4, v6
    v_mul_f32 v176, v176, v3
    v_mul_f32 v177, v177, v3
    v_mul_f32 v178, v178, v3
    v_mul_f32 v179, v179, v3
    v_mul_f32 v180, v180, v3
    v_mul_f32 v181, v181, v3
    v_mul_f32 v182, v182, v3
    v_mul_f32 v183, v183, v3
    v_mul_f32 v184, v184, v3
    v_mul_f32 v185, v185, v3
    v_mul_f32 v186, v186, v3
    v_mul_f32 v187, v187, v3
    v_mul_f32 v188, v188, v3
    v_mul_f32 v189, v189, v3
    v_mul_f32 v190, v190, v3
    v_mul_f32 v191, v191, v3
    v_mul_f32 v192, v192, v3
    v_mul_f32 v193, v193, v3
    v_mul_f32 v194, v194, v3
    v_mul_f32 v195, v195, v3
    v_mul_f32 v196, v196, v3
    v_mul_f32 v197, v197, v3
    v_mul_f32 v198, v198, v3
    v_mul_f32 v199, v199, v3
    v_mul_f32 v200, v200, v3
    v_mul_f32 v201, v201, v3
    v_mul_f32 v202, v202, v3
    v_mul_f32 v203, v203, v3
    v_mul_f32 v204, v204, v3
    v_mul_f32 v205, v205, v3
    v_mul_f32 v206, v206, v3
    v_mul_f32 v207, v207, v3
    s_waitcnt lgkmcnt(5)
    v_fmac_f32 v176, v208, v4
    v_fmac_f32 v177, v209, v4
    v_fmac_f32 v178, v210, v4
    v_fmac_f32 v179, v211, v4
    v_fmac_f32 v180, v212, v4
    v_fmac_f32 v181, v213, v4
    v_fmac_f32 v182, v214, v4
    v_fmac_f32 v183, v215, v4
    v_fmac_f32 v184, v216, v4
    v_fmac_f32 v185, v217, v4
    v_fmac_f32 v186, v218, v4
    v_fmac_f32 v187, v219, v4
    v_fmac_f32 v188, v220, v4
    v_fmac_f32 v189, v221, v4
    v_fmac_f32 v190, v222, v4
    v_fmac_f32 v191, v223, v4
    s_waitcnt lgkmcnt(1)
    v_fmac_f32 v192, v224, v4
    v_fmac_f32 v193, v225, v4
    v_fmac_f32 v194, v226, v4
    v_fmac_f32 v195, v227, v4
    v_fmac_f32 v196, v228, v4
    v_fmac_f32 v197, v229, v4
    v_fmac_f32 v198, v230, v4
    v_fmac_f32 v199, v231, v4
    v_fmac_f32 v200, v232, v4
    v_fmac_f32 v201, v233, v4
    v_fmac_f32 v202, v234, v4
    v_fmac_f32 v203, v235, v4
    v_fmac_f32 v204, v236, v4
    v_fmac_f32 v205, v237, v4
    v_fmac_f32 v206, v238, v4
    v_fmac_f32 v207, v239, v4
    s_barrier
    v_cvt_pk_bf16_f32 v112, v176, v177
    v_cvt_pk_bf16_f32 v113, v178, v179
    v_cvt_pk_bf16_f32 v114, v184, v185
    v_cvt_pk_bf16_f32 v115, v186, v187
    v_cvt_pk_bf16_f32 v116, v180, v181
    v_cvt_pk_bf16_f32 v117, v182, v183
    v_cvt_pk_bf16_f32 v118, v188, v189
    v_cvt_pk_bf16_f32 v119, v190, v191
    v_cvt_pk_bf16_f32 v120, v192, v193
    v_cvt_pk_bf16_f32 v121, v194, v195
    v_cvt_pk_bf16_f32 v122, v200, v201
    v_cvt_pk_bf16_f32 v123, v202, v203
    v_cvt_pk_bf16_f32 v124, v196, v197
    v_cvt_pk_bf16_f32 v125, v198, v199
    v_cvt_pk_bf16_f32 v126, v204, v205
    v_cvt_pk_bf16_f32 v127, v206, v207
    v_and_b32 v2, 15, v1
    v_lshrrev_b32 v3, 5, v1
    v_lshl_add_u32 v2, v3, 4, v2
    v_lshlrev_b32 v2, 4, v2
    v_bfe_u32 v3, v1, 4, 1
    v_lshl_add_u32 v2, v3, 12, v2
    s_lshl_b32 s49, s54, 14
    s_lshl_b32 s50, s40, 13
    s_add_u32 s49, s49, s50
    s_lshl_b32 s50, s41, 11
    s_add_u32 s49, s49, s50
    buffer_store_dwordx4 v[112:115], v2, s[32:35], s49 offen offset:0 sc1
    buffer_store_dwordx4 v[116:119], v2, s[32:35], s49 offen offset:512 sc1
    buffer_store_dwordx4 v[120:123], v2, s[32:35], s49 offen offset:1024 sc1
    buffer_store_dwordx4 v[124:127], v2, s[32:35], s49 offen offset:1536 sc1
K1_TAIL:
    s_cmp_lt_u32 s36, 4
    s_cbranch_scc0 T_E4L
    s_waitcnt vmcnt(0) lgkmcnt(0)
    s_branch T_E4
T_E4L:
    s_waitcnt lgkmcnt(0)
T_E4:
    v_readfirstlane_b32 s84, v8
    v_readfirstlane_b32 s85, v9
    s_barrier
    s_and_b32 s40, s36, 3
    s_lshr_b32 s41, s36, 2
    v_lshlrev_b32 v5, 4, v1
    v_mov_b32 v6, 38920
    ds_read_b32 v12, v6
    s_cmp_eq_u32 s36, 7
    s_cbranch_scc0 T_F0
    v_mov_b32 v9, s84
    s_lshl_b32 s49, s54, 7
    s_add_u32 s49, s49, 16777216
    v_mov_b32 v3, 0
    v_cmp_eq_u32 vcc, 0, v1
    s_and_saveexec_b64 s[58:59], vcc
    buffer_store_dword v9, v3, s[32:35], s49 offen sc1
    s_mov_b64 exec, s[58:59]
T_F0:
    s_waitcnt lgkmcnt(0)
    v_readfirstlane_b32 s52, v12
    s_cmp_eq_u32 s52, 0
    s_cbranch_scc1 T_SLOW
    s_and_b32 s49, s54, 0xfc
    s_lshl_b32 s50, s41, 1
    s_add_u32 s49, s49, s50
    s_lshl_b32 s49, s49, 14
    s_lshl_b32 s50, s40, 12
    s_add_u32 s49, s49, s50
    s_add_u32 s50, s49, 16384
    buffer_load_dwordx4 v[64:67], v5, s[32:35], s49 offen offset:0 sc1
    buffer_load_dwordx4 v[68:71], v5, s[32:35], s49 offen offset:1024 sc1
    buffer_load_dwordx4 v[72:75], v5, s[32:35], s49 offen offset:2048 sc1
    buffer_load_dwordx4 v[76:79], v5, s[32:35], s49 offen offset:3072 sc1
    buffer_load_dwordx4 v[80:83], v5, s[32:35], s50 offen offset:0 sc1
    buffer_load_dwordx4 v[84:87], v5, s[32:35], s50 offen offset:1024 sc1
    buffer_load_dwordx4 v[88:91], v5, s[32:35], s50 offen offset:2048 sc1
    buffer_load_dwordx4 v[92:95], v5, s[32:35], s50 offen offset:3072 sc1
T_SLOW:
    s_cmp_eq_u32 s36, 7
    s_cbranch_scc0 T_NOFLAG
    s_cmp_eq_u32 s52, 0
    s_cbranch_scc0 T_SETUP
    s_and_b32 s49, s54, 0xfc
    s_lshl_b32 s49, s49, 7
    s_add_u32 s49, s49, 16777216
    v_and_b32 v8, 3, v1
    v_lshlrev_b32 v8, 7, v8
    s_mov_b32 s50, 0
    buffer_load_dword v10, v8, s[32:35], s49 offen sc1
    buffer_load_dword v11, v8, s[32:35], s49 offen sc1
    s_branch T_SETUP
T_NOFLAG:
T_SETUP:
T_NOLATE:
    v_lshrrev_b32 v2, 4, v1
    v_and_b32 v3, 15, v1
    v_lshrrev_b32 v4, 2, v3
    v_and_b32 v6, 3, v3
    v_lshl_add_u32 v2, v2, 2, v4
    v_mul_u32_u24 v2, 288, v2
    v_lshl_add_u32 v19, v6, 3, v2
    s_and_b32 s86, s84, 0xfff
    s_lshr_b32 s87, s84, 12
    s_and_b32 s87, s87, 0xfff
    s_lshr_b32 s88, s84, 24
    s_lshl_b32 s51, s85, 8
    s_or_b32 s88, s88, s51
    s_and_b32 s88, s88, 0xfff
    s_lshr_b32 s89, s85, 4
    s_and_b32 s89, s89, 0xfff
    v_mov_b32 v7, 0xfffff000
    s_lshl_b32 s86, s84, 16
    s_and_b32 s87, s84, 0xffff0000
    s_lshl_b32 s51, s85, 16
    s_xor_b32 s88, s86, s51
    s_xor_b32 s88, s88, 0x5a5a0000
    s_xor_b32 s89, s87, s51
    s_xor_b32 s89, s89, 0xa5c30000
    v_and_b32 v3, 3, v1
    v_mov_b32 v22, s86
    v_mov_b32 v4, s87
    v_cmp_eq_u32 vcc, 1, v3
    s_nop 1
    v_cndmask_b32 v22, v22, v4, vcc
    v_mov_b32 v4, s88
    v_cmp_eq_u32 vcc, 2, v3
    s_nop 1
    v_cndmask_b32 v22, v22, v4, vcc
    v_mov_b32 v4, s89
    v_cmp_eq_u32 vcc, 3, v3
    s_nop 1
    v_cndmask_b32 v22, v22, v4, vcc
    v_mov_b32 v28, 0
    v_mov_b32 v29, 0
    v_mov_b32 v30, 0
    v_mov_b32 v31, 0
    v_mov_b32 v32, 0
    v_mov_b32 v33, 0
    v_mov_b32 v34, 0
    v_mov_b32 v35, 0
    v_mov_b32 v36, 0
    v_mov_b32 v37, 0
    v_mov_b32 v38, 0
    v_mov_b32 v39, 0
    v_mov_b32 v40, 0
    v_mov_b32 v41, 0
    v_mov_b32 v42, 0
    v_mov_b32 v43, 0
    v_mov_b32 v44, 0
    v_mov_b32 v45, 0
    v_mov_b32 v46, 0
    v_mov_b32 v47, 0
    v_mov_b32 v48, 0
    v_mov_b32 v49, 0
    v_mov_b32 v50, 0
    v_mov_b32 v51, 0
    v_mov_b32 v52, 0
    v_mov_b32 v53, 0
    v_mov_b32 v54, 0
    v_mov_b32 v55, 0
    v_mov_b32 v56, 0
    v_mov_b32 v57, 0
    v_mov_b32 v58, 0
    v_mov_b32 v59, 0
    v_mov_b32 v60, 0
    v_mov_b32 v61, 0
    v_mov_b32 v62, 0
    v_mov_b32 v63, 0
    s_cmp_eq_u32 s36, 7
    s_cbranch_scc0 T_NOPOLL
    s_cmp_eq_u32 s52, 0
    s_cbranch_scc0 T_NOPOLL
    s_and_b32 s49, s54, 0xfc
    s_lshl_b32 s49, s49, 7
    s_add_u32 s49, s49, 16777216
    s_mov_b32 s50, 0
T_POLL1:
    s_waitcnt vmcnt(1)
    v_cmp_ne_u32 vcc, v10, v9
    s_cbranch_vccz T_NOPOLL
    buffer_load_dword v10, v8, s[32:35], s49 offen sc1
    s_add_u32 s50, s50, 1
    s_waitcnt vmcnt(1)
    v_cmp_ne_u32 vcc, v11, v9
    s_cbranch_vccz T_NOPOLL
    buffer_load_dword v11, v8, s[32:35], s49 offen sc1
    s_cmp_lt_u32 s50, 262144
    s_cbranch_scc1 T_POLL1
T_NOPOLL:
    s_waitcnt vmcnt(0)
    s_barrier
    s_cmp_eq_u32 s52, 0
    s_cbranch_scc0 T_BDONE
    s_and_b32 s49, s54, 0xfc
    s_lshl_b32 s50, s41, 1
    s_add_u32 s49, s49, s50
    s_lshl_b32 s49, s49, 14
    s_lshl_b32 s50, s40, 12
    s_add_u32 s49, s49, s50
    s_add_u32 s50, s49, 16384
    buffer_load_dwordx4 v[64:67], v5, s[32:35], s49 offen offset:0 sc1
    buffer_load_dwordx4 v[68:71], v5, s[32:35], s49 offen offset:1024 sc1
    buffer_load_dwordx4 v[72:75], v5, s[32:35], s49 offen offset:2048 sc1
    buffer_load_dwordx4 v[76:79], v5, s[32:35], s49 offen offset:3072 sc1
    buffer_load_dwordx4 v[80:83], v5, s[32:35], s50 offen offset:0 sc1
    buffer_load_dwordx4 v[84:87], v5, s[32:35], s50 offen offset:1024 sc1
    buffer_load_dwordx4 v[88:91], v5, s[32:35], s50 offen offset:2048 sc1
    buffer_load_dwordx4 v[92:95], v5, s[32:35], s50 offen offset:3072 sc1
T_BDONE:
    s_mov_b32 s51, 122880
    s_cmp_eq_u32 s41, 0
    s_cselect_b32 s51, 49152, s51
    v_add_u32 v20, s51, v19
    s_mov_b32 s51, 0
    s_cmp_eq_u32 s41, 0
    s_cselect_b32 s51, 86016, s51
    v_add_u32 v21, s51, v19
    ds_read_b64_tr_b16 v[96:97], v20 offset:0
    ds_read_b64_tr_b16 v[98:99], v20 offset:4608
    ds_read_b64_tr_b16 v[100:101], v20 offset:32
    ds_read_b64_tr_b16 v[102:103], v20 offset:4640
    ds_read_b64_tr_b16 v[104:105], v20 offset:64
    ds_read_b64_tr_b16 v[106:107], v20 offset:4672
    ds_read_b64_tr_b16 v[108:109], v20 offset:96
    ds_read_b64_tr_b16 v[110:111], v20 offset:4704
    ds_read_b64_tr_b16 v[112:113], v20 offset:128
    ds_read_b64_tr_b16 v[114:115], v20 offset:4736
    ds_read_b64_tr_b16 v[116:117], v20 offset:160
    ds_read_b64_tr_b16 v[118:119], v20 offset:4768
    ds_read_b64_tr_b16 v[120:121], v20 offset:192
    ds_read_b64_tr_b16 v[122:123], v20 offset:4800
    ds_read_b64_tr_b16 v[124:125], v20 offset:224
    ds_read_b64_tr_b16 v[126:127], v20 offset:4832
    ds_read_b64_tr_b16 v[128:129], v20 offset:256
    ds_read_b64_tr_b16 v[130:131], v20 offset:4864
    s_waitcnt vmcnt(7) lgkmcnt(8)
    v_mfma_f32_16x16x32_bf16 v[28:31], v[96:99], v[64:67], v[28:31]
    v_mfma_f32_16x16x32_bf16 v[32:35], v[100:103], v[64:67], v[32:35]
    v_mfma_f32_16x16x32_bf16 v[36:39], v[104:107], v[64:67], v[36:39]
    v_mfma_f32_16x16x32_bf16 v[40:43], v[108:111], v[64:67], v[40:43]
    v_mfma_f32_16x16x32_bf16 v[44:47], v[112:115], v[64:67], v[44:47]
    ds_read_b64_tr_b16 v[96:97], v20 offset:9216
    ds_read_b64_tr_b16 v[98:99], v20 offset:13824
    ds_read_b64_tr_b16 v[100:101], v20 offset:9248
    ds_read_b64_tr_b16 v[102:103], v20 offset:13856
    ds_read_b64_tr_b16 v[104:105], v20 offset:9280
    ds_read_b64_tr_b16 v[106:107], v20 offset:13888
    ds_read_b64_tr_b16 v[108:109], v20 offset:9312
    ds_read_b64_tr_b16 v[110:111], v20 offset:13920
    ds_read_b64_tr_b16 v[112:113], v20 offset:9344
    ds_read_b64_tr_b16 v[114:115], v20 offset:13952
    s_waitcnt lgkmcnt(10)
    v_mfma_f32_16x16x32_bf16 v[48:51], v[116:119], v[64:67], v[48:51]
    v_mfma_f32_16x16x32_bf16 v[52:55], v[120:123], v[64:67], v[52:55]
    v_mfma_f32_16x16x32_bf16 v[56:59], v[124:127], v[64:67], v[56:59]
    v_mfma_f32_16x16x32_bf16 v[60:63], v[128:131], v[64:67], v[60:63]
    ds_read_b64_tr_b16 v[116:117], v20 offset:9376
    ds_read_b64_tr_b16 v[118:119], v20 offset:13984
    ds_read_b64_tr_b16 v[120:121], v20 offset:9408
    ds_read_b64_tr_b16 v[122:123], v20 offset:14016
    ds_read_b64_tr_b16 v[124:125], v20 offset:9440
    ds_read_b64_tr_b16 v[126:127], v20 offset:14048
    ds_read_b64_tr_b16 v[128:129], v20 offset:9472
    ds_read_b64_tr_b16 v[130:131], v20 offset:14080
    s_waitcnt vmcnt(6) lgkmcnt(8)
    v_mfma_f32_16x16x32_bf16 v[28:31], v[96:99], v[68:71], v[28:31]
    v_mfma_f32_16x16x32_bf16 v[32:35], v[100:103], v[68:71], v[32:35]
    v_mfma_f32_16x16x32_bf16 v[36:39], v[104:107], v[68:71], v[36:39]
    v_mfma_f32_16x16x32_bf16 v[40:43], v[108:111], v[68:71], v[40:43]
    v_mfma_f32_16x16x32_bf16 v[44:47], v[112:115], v[68:71], v[44:47]
    ds_read_b64_tr_b16 v[96:97], v20 offset:18432
    ds_read_b64_tr_b16 v[98:99], v20 offset:23040
    ds_read_b64_tr_b16 v[100:101], v20 offset:18464
    ds_read_b64_tr_b16 v[102:103], v20 offset:23072
    ds_read_b64_tr_b16 v[104:105], v20 offset:18496
    ds_read_b64_tr_b16 v[106:107], v20 offset:23104
    ds_read_b64_tr_b16 v[108:109], v20 offset:18528
    ds_read_b64_tr_b16 v[110:111], v20 offset:23136
    ds_read_b64_tr_b16 v[112:113], v20 offset:18560
    ds_read_b64_tr_b16 v[114:115], v20 offset:23168
    s_waitcnt lgkmcnt(10)
    v_mfma_f32_16x16x32_bf16 v[48:51], v[116:119], v[68:71], v[48:51]
    v_mfma_f32_16x16x32_bf16 v[52:55], v[120:123], v[68:71], v[52:55]
    v_mfma_f32_16x16x32_bf16 v[56:59], v[124:127], v[68:71], v[56:59]
    v_mfma_f32_16x16x32_bf16 v[60:63], v[128:131], v[68:71], v[60:63]
    ds_read_b64_tr_b16 v[116:117], v20 offset:18592
    ds_read_b64_tr_b16 v[118:119], v20 offset:23200
    ds_read_b64_tr_b16 v[120:121], v20 offset:18624
    ds_read_b64_tr_b16 v[122:123], v20 offset:23232
    ds_read_b64_tr_b16 v[124:125], v20 offset:18656
    ds_read_b64_tr_b16 v[126:127], v20 offset:23264
    ds_read_b64_tr_b16 v[128:129], v20 offset:18688
    ds_read_b64_tr_b16 v[130:131], v20 offset:23296
    s_waitcnt vmcnt(5) lgkmcnt(8)
    v_mfma_f32_16x16x32_bf16 v[28:31], v[96:99], v[72:75], v[28:31]
    v_mfma_f32_16x16x32_bf16 v[32:35], v[100:103], v[72:75], v[32:35]
    v_mfma_f32_16x16x32_bf16 v[36:39], v[104:107], v[72:75], v[36:39]
    v_mfma_f32_16x16x32_bf16 v[40:43], v[108:111], v[72:75], v[40:43]
    v_mfma_f32_16x16x32_bf16 v[44:47], v[112:115], v[72:75], v[44:47]
    ds_read_b64_tr_b16 v[96:97], v20 offset:27648
    ds_read_b64_tr_b16 v[98:99], v20 offset:32256
    ds_read_b64_tr_b16 v[100:101], v20 offset:27680
    ds_read_b64_tr_b16 v[102:103], v20 offset:32288
    ds_read_b64_tr_b16 v[104:105], v20 offset:27712
    ds_read_b64_tr_b16 v[106:107], v20 offset:32320
    ds_read_b64_tr_b16 v[108:109], v20 offset:27744
    ds_read_b64_tr_b16 v[110:111], v20 offset:32352
    ds_read_b64_tr_b16 v[112:113], v20 offset:27776
    ds_read_b64_tr_b16 v[114:115], v20 offset:32384
    s_waitcnt lgkmcnt(10)
    v_mfma_f32_16x16x32_bf16 v[48:51], v[116:119], v[72:75], v[48:51]
    v_mfma_f32_16x16x32_bf16 v[52:55], v[120:123], v[72:75], v[52:55]
    v_mfma_f32_16x16x32_bf16 v[56:59], v[124:127], v[72:75], v[56:59]
    v_mfma_f32_16x16x32_bf16 v[60:63], v[128:131], v[72:75], v[60:63]
    ds_read_b64_tr_b16 v[116:117], v20 offset:27808
    ds_read_b64_tr_b16 v[118:119], v20 offset:32416
    ds_read_b64_tr_b16 v[120:121], v20 offset:27840
    ds_read_b64_tr_b16 v[122:123], v20 offset:32448
    ds_read_b64_tr_b16 v[124:125], v20 offset:27872
    ds_read_b64_tr_b16 v[126:127], v20 offset:32480
    ds_read_b64_tr_b16 v[128:129], v20 offset:27904
    ds_read_b64_tr_b16 v[130:131], v20 offset:32512
    s_waitcnt vmcnt(4) lgkmcnt(8)
    v_mfma_f32_16x16x32_bf16 v[28:31], v[96:99], v[76:79], v[28:31]
    v_mfma_f32_16x16x32_bf16 v[32:35], v[100:103], v[76:79], v[32:35]
    v_mfma_f32_16x16x32_bf16 v[36:39], v[104:107], v[76:79], v[36:39]
    v_mfma_f32_16x16x32_bf16 v[40:43], v[108:111], v[76:79], v[40:43]
    v_mfma_f32_16x16x32_bf16 v[44:47], v[112:115], v[76:79], v[44:47]
    ds_read_b64_tr_b16 v[96:97], v21 offset:0
    ds_read_b64_tr_b16 v[98:99], v21 offset:4608
    ds_read_b64_tr_b16 v[100:101], v21 offset:32
    ds_read_b64_tr_b16 v[102:103], v21 offset:4640
    ds_read_b64_tr_b16 v[104:105], v21 offset:64
    ds_read_b64_tr_b16 v[106:107], v21 offset:4672
    ds_read_b64_tr_b16 v[108:109], v21 offset:96
    ds_read_b64_tr_b16 v[110:111], v21 offset:4704
    ds_read_b64_tr_b16 v[112:113], v21 offset:128
    ds_read_b64_tr_b16 v[114:115], v21 offset:4736
    s_waitcnt lgkmcnt(10)
    v_mfma_f32_16x16x32_bf16 v[48:51], v[116:119], v[76:79], v[48:51]
    v_mfma_f32_16x16x32_bf16 v[52:55], v[120:123], v[76:79], v[52:55]
    v_mfma_f32_16x16x32_bf16 v[56:59], v[124:127], v[76:79], v[56:59]
    v_mfma_f32_16x16x32_bf16 v[60:63], v[128:131], v[76:79], v[60:63]
    ds_read_b64_tr_b16 v[116:117], v21 offset:160
    ds_read_b64_tr_b16 v[118:119], v21 offset:4768
    ds_read_b64_tr_b16 v[120:121], v21 offset:192
    ds_read_b64_tr_b16 v[122:123], v21 offset:4800
    ds_read_b64_tr_b16 v[124:125], v21 offset:224
    ds_read_b64_tr_b16 v[126:127], v21 offset:4832
    ds_read_b64_tr_b16 v[128:129], v21 offset:256
    ds_read_b64_tr_b16 v[130:131], v21 offset:4864
    s_waitcnt vmcnt(3) lgkmcnt(8)
    v_mfma_f32_16x16x32_bf16 v[28:31], v[96:99], v[80:83], v[28:31]
    v_mfma_f32_16x16x32_bf16 v[32:35], v[100:103], v[80:83], v[32:35]
    v_mfma_f32_16x16x32_bf16 v[36:39], v[104:107], v[80:83], v[36:39]
    v_mfma_f32_16x16x32_bf16 v[40:43], v[108:111], v[80:83], v[40:43]
    v_mfma_f32_16x16x32_bf16 v[44:47], v[112:115], v[80:83], v[44:47]
    ds_read_b64_tr_b16 v[96:97], v21 offset:9216
    ds_read_b64_tr_b16 v[98:99], v21 offset:13824
    ds_read_b64_tr_b16 v[100:101], v21 offset:9248
    ds_read_b64_tr_b16 v[102:103], v21 offset:13856
    ds_read_b64_tr_b16 v[104:105], v21 offset:9280
    ds_read_b64_tr_b16 v[106:107], v21 offset:13888
    ds_read_b64_tr_b16 v[108:109], v21 offset:9312
    ds_read_b64_tr_b16 v[110:111], v21 offset:13920
    ds_read_b64_tr_b16 v[112:113], v21 offset:9344
    ds_read_b64_tr_b16 v[114:115], v21 offset:13952
    s_waitcnt lgkmcnt(10)
    v_mfma_f32_16x16x32_bf16 v[48:51], v[116:119], v[80:83], v[48:51]
    v_mfma_f32_16x16x32_bf16 v[52:55], v[120:123], v[80:83], v[52:55]
    v_mfma_f32_16x16x32_bf16 v[56:59], v[124:127], v[80:83], v[56:59]
    v_mfma_f32_16x16x32_bf16 v[60:63], v[128:131], v[80:83], v[60:63]
    ds_read_b64_tr_b16 v[116:117], v21 offset:9376
    ds_read_b64_tr_b16 v[118:119], v21 offset:13984
    ds_read_b64_tr_b16 v[120:121], v21 offset:9408
    ds_read_b64_tr_b16 v[122:123], v21 offset:14016
    ds_read_b64_tr_b16 v[124:125], v21 offset:9440
    ds_read_b64_tr_b16 v[126:127], v21 offset:14048
    ds_read_b64_tr_b16 v[128:129], v21 offset:9472
    ds_read_b64_tr_b16 v[130:131], v21 offset:14080
    s_waitcnt vmcnt(2) lgkmcnt(8)
    v_mfma_f32_16x16x32_bf16 v[28:31], v[96:99], v[84:87], v[28:31]
    v_mfma_f32_16x16x32_bf16 v[32:35], v[100:103], v[84:87], v[32:35]
    v_mfma_f32_16x16x32_bf16 v[36:39], v[104:107], v[84:87], v[36:39]
    v_mfma_f32_16x16x32_bf16 v[40:43], v[108:111], v[84:87], v[40:43]
    v_mfma_f32_16x16x32_bf16 v[44:47], v[112:115], v[84:87], v[44:47]
    ds_read_b64_tr_b16 v[96:97], v21 offset:18432
    ds_read_b64_tr_b16 v[98:99], v21 offset:23040
    ds_read_b64_tr_b16 v[100:101], v21 offset:18464
    ds_read_b64_tr_b16 v[102:103], v21 offset:23072
    ds_read_b64_tr_b16 v[104:105], v21 offset:18496
    ds_read_b64_tr_b16 v[106:107], v21 offset:23104
    ds_read_b64_tr_b16 v[108:109], v21 offset:18528
    ds_read_b64_tr_b16 v[110:111], v21 offset:23136
    ds_read_b64_tr_b16 v[112:113], v21 offset:18560
    ds_read_b64_tr_b16 v[114:115], v21 offset:23168
    s_waitcnt lgkmcnt(10)
    v_mfma_f32_16x16x32_bf16 v[48:51], v[116:119], v[84:87], v[48:51]
    v_mfma_f32_16x16x32_bf16 v[52:55], v[120:123], v[84:87], v[52:55]
    v_mfma_f32_16x16x32_bf16 v[56:59], v[124:127], v[84:87], v[56:59]
    v_mfma_f32_16x16x32_bf16 v[60:63], v[128:131], v[84:87], v[60:63]
    ds_read_b64_tr_b16 v[116:117], v21 offset:18592
    ds_read_b64_tr_b16 v[118:119], v21 offset:23200
    ds_read_b64_tr_b16 v[120:121], v21 offset:18624
    ds_read_b64_tr_b16 v[122:123], v21 offset:23232
    ds_read_b64_tr_b16 v[124:125], v21 offset:18656
    ds_read_b64_tr_b16 v[126:127], v21 offset:23264
    ds_read_b64_tr_b16 v[128:129], v21 offset:18688
    ds_read_b64_tr_b16 v[130:131], v21 offset:23296
    s_waitcnt vmcnt(1) lgkmcnt(8)
    v_mfma_f32_16x16x32_bf16 v[28:31], v[96:99], v[88:91], v[28:31]
    v_mfma_f32_16x16x32_bf16 v[32:35], v[100:103], v[88:91], v[32:35]
    v_mfma_f32_16x16x32_bf16 v[36:39], v[104:107], v[88:91], v[36:39]
    v_mfma_f32_16x16x32_bf16 v[40:43], v[108:111], v[88:91], v[40:43]
    v_mfma_f32_16x16x32_bf16 v[44:47], v[112:115], v[88:91], v[44:47]
    ds_read_b64_tr_b16 v[96:97], v21 offset:27648
    ds_read_b64_tr_b16 v[98:99], v21 offset:32256
    ds_read_b64_tr_b16 v[100:101], v21 offset:27680
    ds_read_b64_tr_b16 v[102:103], v21 offset:32288
    ds_read_b64_tr_b16 v[104:105], v21 offset:27712
    ds_read_b64_tr_b16 v[106:107], v21 offset:32320
    ds_read_b64_tr_b16 v[108:109], v21 offset:27744
    ds_read_b64_tr_b16 v[110:111], v21 offset:32352
    ds_read_b64_tr_b16 v[112:113], v21 offset:27776
    ds_read_b64_tr_b16 v[114:115], v21 offset:32384
    s_waitcnt lgkmcnt(10)
    v_mfma_f32_16x16x32_bf16 v[48:51], v[116:119], v[88:91], v[48:51]
    v_mfma_f32_16x16x32_bf16 v[52:55], v[120:123], v[88:91], v[52:55]
    v_mfma_f32_16x16x32_bf16 v[56:59], v[124:127], v[88:91], v[56:59]
    v_mfma_f32_16x16x32_bf16 v[60:63], v[128:131], v[88:91], v[60:63]
    ds_read_b64_tr_b16 v[116:117], v21 offset:27808
    ds_read_b64_tr_b16 v[118:119], v21 offset:32416
    ds_read_b64_tr_b16 v[120:121], v21 offset:27840
    ds_read_b64_tr_b16 v[122:123], v21 offset:32448
    ds_read_b64_tr_b16 v[124:125], v21 offset:27872
    ds_read_b64_tr_b16 v[126:127], v21 offset:32480
    ds_read_b64_tr_b16 v[128:129], v21 offset:27904
    ds_read_b64_tr_b16 v[130:131], v21 offset:32512
    s_waitcnt vmcnt(0) lgkmcnt(8)
    v_mfma_f32_16x16x32_bf16 v[28:31], v[96:99], v[92:95], v[28:31]
    v_mfma_f32_16x16x32_bf16 v[32:35], v[100:103], v[92:95], v[32:35]
    v_mfma_f32_16x16x32_bf16 v[36:39], v[104:107], v[92:95], v[36:39]
    v_mfma_f32_16x16x32_bf16 v[40:43], v[108:111], v[92:95], v[40:43]
    v_mfma_f32_16x16x32_bf16 v[44:47], v[112:115], v[92:95], v[44:47]
    s_waitcnt lgkmcnt(0)
    v_mfma_f32_16x16x32_bf16 v[48:51], v[116:119], v[92:95], v[48:51]
    v_mfma_f32_16x16x32_bf16 v[52:55], v[120:123], v[92:95], v[52:55]
    v_mfma_f32_16x16x32_bf16 v[56:59], v[124:127], v[92:95], v[56:59]
    v_mfma_f32_16x16x32_bf16 v[60:63], v[128:131], v[92:95], v[60:63]
    s_barrier
    s_mul_i32 s49, s40, 9216
    v_add_u32 v2, s49, v5
    s_cmp_eq_u32 s41, 0
    s_cbranch_scc0 T_H1
    ds_write_b128 v2, v[48:51] offset:5120
    ds_write_b128 v2, v[52:55] offset:6144
    ds_write_b128 v2, v[56:59] offset:7168
    ds_write_b128 v2, v[60:63] offset:8192
    s_branch T_H2
T_H1:
    ds_write_b128 v2, v[28:31] offset:0
    ds_write_b128 v2, v[32:35] offset:1024
    ds_write_b128 v2, v[36:39] offset:2048
    ds_write_b128 v2, v[40:43] offset:3072
    ds_write_b128 v2, v[44:47] offset:4096
T_H2:
    s_lshl_b32 s49, s39, 3
    s_add_u32 s49, s49, s37
    s_lshl_b32 s49, s49, 2
    s_add_u32 s49, s49, s47
    s_lshl_b32 s49, s49, 2
    s_add_u32 s49, s49, s40
    s_lshl_b32 s49, s49, 1
    s_add_u32 s49, s49, s41
    s_mul_i32 s49, s49, 3072
    s_add_u32 s49, s49, 4194304
    s_waitcnt lgkmcnt(0)
    s_barrier
    s_cmp_eq_u32 s41, 0
    s_cbranch_scc0 T_H3
    ds_read_b128 v[96:99], v2 offset:0
    ds_read_b128 v[100:103], v2 offset:1024
    ds_read_b128 v[104:107], v2 offset:2048
    ds_read_b128 v[108:111], v2 offset:3072
    ds_read_b128 v[112:115], v2 offset:4096
    s_waitcnt lgkmcnt(4)
    v_add_f32 v28, v28, v96
    v_add_f32 v29, v29, v97
    v_add_f32 v30, v30, v98
    v_add_f32 v31, v31, v99
    s_waitcnt lgkmcnt(3)
    v_add_f32 v32, v32, v100
    v_add_f32 v33, v33, v101
    v_add_f32 v34, v34, v102
    v_add_f32 v35, v35, v103
    s_waitcnt lgkmcnt(2)
    v_add_f32 v36, v36, v104
    v_add_f32 v37, v37, v105
    v_add_f32 v38, v38, v106
    v_add_f32 v39, v39, v107
    s_waitcnt lgkmcnt(1)
    v_add_f32 v40, v40, v108
    v_add_f32 v41, v41, v109
    v_add_f32 v42, v42, v110
    v_add_f32 v43, v43, v111
    s_waitcnt lgkmcnt(0)
    v_add_f32 v44, v44, v112
    v_add_f32 v45, v45, v113
    v_add_f32 v46, v46, v114
    v_add_f32 v47, v47, v115
    v_cvt_pk_bf16_f32 v140, v28, v29
    v_cvt_pk_bf16_f32 v141, v30, v31
    v_cvt_pk_bf16_f32 v142, v32, v33
    v_cvt_pk_bf16_f32 v143, v34, 0
    v_or_b32 v143, v143, v22
    buffer_store_dwordx4 v[140:143], v5, s[32:35], s49 offen offset:0 sc1
    v_cvt_pk_bf16_f32 v144, v35, v36
    v_cvt_pk_bf16_f32 v145, v37, v38
    v_cvt_pk_bf16_f32 v146, v39, v40
    v_cvt_pk_bf16_f32 v147, v41, 0
    v_or_b32 v147, v147, v22
    buffer_store_dwordx4 v[144:147], v5, s[32:35], s49 offen offset:1024 sc1
    v_cvt_pk_bf16_f32 v148, v42, v43
    v_cvt_pk_bf16_f32 v149, v44, v45
    v_cvt_pk_bf16_f32 v150, v46, v47
    v_mov_b32 v151, v22
    buffer_store_dwordx4 v[148:151], v5, s[32:35], s49 offen offset:2048 sc1
    s_branch T_H4
T_H3:
    ds_read_b128 v[116:119], v2 offset:5120
    ds_read_b128 v[120:123], v2 offset:6144
    ds_read_b128 v[124:127], v2 offset:7168
    ds_read_b128 v[128:131], v2 offset:8192
    s_waitcnt lgkmcnt(3)
    v_add_f32 v48, v48, v116
    v_add_f32 v49, v49, v117
    v_add_f32 v50, v50, v118
    v_add_f32 v51, v51, v119
    s_waitcnt lgkmcnt(2)
    v_add_f32 v52, v52, v120
    v_add_f32 v53, v53, v121
    v_add_f32 v54, v54, v122
    v_add_f32 v55, v55, v123
    s_waitcnt lgkmcnt(1)
    v_add_f32 v56, v56, v124
    v_add_f32 v57, v57, v125
    v_add_f32 v58, v58, v126
    v_add_f32 v59, v59, v127
    s_waitcnt lgkmcnt(0)
    v_add_f32 v60, v60, v128
    v_add_f32 v61, v61, v129
    v_add_f32 v62, v62, v130
    v_add_f32 v63, v63, v131
    v_cvt_pk_bf16_f32 v140, v48, v49
    v_cvt_pk_bf16_f32 v141, v50, v51
    v_cvt_pk_bf16_f32 v142, v52, v53
    v_cvt_pk_bf16_f32 v143, v54, 0
    v_or_b32 v143, v143, v22
    buffer_store_dwordx4 v[140:143], v5, s[32:35], s49 offen offset:0 sc1
    v_cvt_pk_bf16_f32 v144, v55, v56
    v_cvt_pk_bf16_f32 v145, v57, v58
    v_cvt_pk_bf16_f32 v146, v59, v60
    v_cvt_pk_bf16_f32 v147, v61, 0
    v_or_b32 v147, v147, v22
    buffer_store_dwordx4 v[144:147], v5, s[32:35], s49 offen offset:1024 sc1
    v_cvt_pk_bf16_f32 v148, v62, v63
    v_mov_b32 v149, 0
    v_mov_b32 v150, 0
    v_mov_b32 v151, v22
    buffer_store_dwordx4 v[148:151], v5, s[32:35], s49 offen offset:2048 sc1
T_H4:
    s_cmp_ge_u32 s36, 3
    s_cbranch_scc1 T_DONE
    s_lshl_b32 s49, s37, 2
    s_add_u32 s49, s49, s47
    s_lshl_b32 s49, s49, 3
    s_add_u32 s49, s49, s39
    s_mul_i32 s49, s49, 3072
    s_lshl_b32 s50, s36, 10
    s_add_u32 s49, s49, s50
    s_add_u32 s49, s49, 4194304
    s_mov_b32 s28, s80
    s_mov_b32 s29, s81
    s_mov_b32 s30, 589824
    s_mov_b32 s31, 0x20000
    v_lshlrev_b32 v3, 4, v1
    s_lshr_b32 s50, s39, 1
    s_lshl_b32 s50, s50, 4
    s_lshl_b32 s51, s37, 6
    s_add_u32 s50, s50, s51
    v_and_b32 v4, 15, v1
    v_add_u32 v4, s50, v4
    s_movk_i32 s50, 1152
    v_mul_u32_u24 v4, s50, v4
    v_lshrrev_b32 v6, 4, v1
    v_lshl_add_u32 v4, v6, 3, v4
    s_mul_i32 s50, s47, 288
    s_and_b32 s51, s39, 1
    s_mul_i32 s51, s51, 160
    s_add_u32 s50, s50, s51
    v_add_u32 v4, s50, v4
    s_mov_b32 s51, 0
    s_mov_b64 s[56:57], exec
    v_mul_u32_u24 v6, 768, v1
    v_lshlrev_b32 v6, 10, v6
    v_add_u32 v6, 12, v6
    v_mov_b32 v9, s86
    s_mov_b64 exec, 0xff
    buffer_load_dword v10, v6, s[32:35], s49 offen sc1
    buffer_load_dword v11, v6, s[32:35], s49 offen sc1
T_PP:
    s_waitcnt vmcnt(1)
    v_xor_b32 v8, v10, v9
    v_lshrrev_b32 v8, 16, v8
    v_cmp_ne_u32 vcc, 0, v8
    s_cbranch_vccz T_PPD
    buffer_load_dword v10, v6, s[32:35], s49 offen sc1
    s_add_u32 s51, s51, 1
    s_waitcnt vmcnt(1)
    v_xor_b32 v8, v11, v9
    v_lshrrev_b32 v8, 16, v8
    v_cmp_ne_u32 vcc, 0, v8
    s_cbranch_vccz T_PPD
    buffer_load_dword v11, v6, s[32:35], s49 offen sc1
    s_cmp_lt_u32 s51, 262144
    s_cbranch_scc1 T_PP
T_PPD:
    s_mov_b64 exec, s[56:57]
    s_mov_b32 s51, 0
T_POLL2:
    s_mov_b32 s50, s49
    buffer_load_dwordx4 v[100:103], v3, s[32:35], s50 offen sc1
    s_add_u32 s50, s50, 786432
    buffer_load_dwordx4 v[104:107], v3, s[32:35], s50 offen sc1
    s_add_u32 s50, s50, 786432
    buffer_load_dwordx4 v[108:111], v3, s[32:35], s50 offen sc1
    s_add_u32 s50, s50, 786432
    buffer_load_dwordx4 v[112:115], v3, s[32:35], s50 offen sc1
    s_add_u32 s50, s50, 786432
    buffer_load_dwordx4 v[116:119], v3, s[32:35], s50 offen sc1
    s_add_u32 s50, s50, 786432
    buffer_load_dwordx4 v[120:123], v3, s[32:35], s50 offen sc1
    s_add_u32 s50, s50, 786432
    buffer_load_dwordx4 v[124:127], v3, s[32:35], s50 offen sc1
    s_add_u32 s50, s50, 786432
    buffer_load_dwordx4 v[128:131], v3, s[32:35], s50 offen sc1
    s_add_u32 s51, s51, 1
    v_mov_b32 v6, 0
    s_waitcnt vmcnt(7)
    v_xor_b32 v8, v103, v22
    v_or_b32 v6, v6, v8
    s_waitcnt vmcnt(6)
    v_xor_b32 v8, v107, v22
    v_or_b32 v6, v6, v8
    s_waitcnt vmcnt(5)
    v_xor_b32 v8, v111, v22
    v_or_b32 v6, v6, v8
    s_waitcnt vmcnt(4)
    v_xor_b32 v8, v115, v22
    v_or_b32 v6, v6, v8
    s_waitcnt vmcnt(3)
    v_xor_b32 v8, v119, v22
    v_or_b32 v6, v6, v8
    s_waitcnt vmcnt(2)
    v_xor_b32 v8, v123, v22
    v_or_b32 v6, v6, v8
    s_waitcnt vmcnt(1)
    v_xor_b32 v8, v127, v22
    v_or_b32 v6, v6, v8
    s_waitcnt vmcnt(0)
    v_xor_b32 v8, v131, v22
    v_or_b32 v6, v6, v8
    v_lshrrev_b32 v6, 16, v6
    v_cmp_ne_u32 vcc, 0, v6
    s_cmp_lt_u32 s51, 262144
    s_cbranch_scc0 T_SUM
    s_cbranch_vccnz T_POLL2
T_SUM:
    v_mov_b32 v7, 0xffff0000
    v_lshlrev_b32 v140, 16, v100
    v_and_b32 v141, v7, v100
    v_lshlrev_b32 v142, 16, v101
    v_and_b32 v143, v7, v101
    v_lshlrev_b32 v144, 16, v102
    v_and_b32 v145, v7, v102
    v_lshlrev_b32 v146, 16, v103
    v_lshlrev_b32 v8, 16, v104
    v_add_f32 v140, v140, v8
    v_and_b32 v8, v7, v104
    v_add_f32 v141, v141, v8
    v_lshlrev_b32 v8, 16, v105
    v_add_f32 v142, v142, v8
    v_and_b32 v8, v7, v105
    v_add_f32 v143, v143, v8
    v_lshlrev_b32 v8, 16, v106
    v_add_f32 v144, v144, v8
    v_and_b32 v8, v7, v106
    v_add_f32 v145, v145, v8
    v_lshlrev_b32 v8, 16, v107
    v_add_f32 v146, v146, v8
    v_lshlrev_b32 v8, 16, v108
    v_add_f32 v140, v140, v8
    v_and_b32 v8, v7, v108
    v_add_f32 v141, v141, v8
    v_lshlrev_b32 v8, 16, v109
    v_add_f32 v142, v142, v8
    v_and_b32 v8, v7, v109
    v_add_f32 v143, v143, v8
    v_lshlrev_b32 v8, 16, v110
    v_add_f32 v144, v144, v8
    v_and_b32 v8, v7, v110
    v_add_f32 v145, v145, v8
    v_lshlrev_b32 v8, 16, v111
    v_add_f32 v146, v146, v8
    v_lshlrev_b32 v8, 16, v112
    v_add_f32 v140, v140, v8
    v_and_b32 v8, v7, v112
    v_add_f32 v141, v141, v8
    v_lshlrev_b32 v8, 16, v113
    v_add_f32 v142, v142, v8
    v_and_b32 v8, v7, v113
    v_add_f32 v143, v143, v8
    v_lshlrev_b32 v8, 16, v114
    v_add_f32 v144, v144, v8
    v_and_b32 v8, v7, v114
    v_add_f32 v145, v145, v8
    v_lshlrev_b32 v8, 16, v115
    v_add_f32 v146, v146, v8
    v_lshlrev_b32 v8, 16, v116
    v_add_f32 v140, v140, v8
    v_and_b32 v8, v7, v116
    v_add_f32 v141, v141, v8
    v_lshlrev_b32 v8, 16, v117
    v_add_f32 v142, v142, v8
    v_and_b32 v8, v7, v117
    v_add_f32 v143, v143, v8
    v_lshlrev_b32 v8, 16, v118
    v_add_f32 v144, v144, v8
    v_and_b32 v8, v7, v118
    v_add_f32 v145, v145, v8
    v_lshlrev_b32 v8, 16, v119
    v_add_f32 v146, v146, v8
    v_lshlrev_b32 v8, 16, v120
    v_add_f32 v140, v140, v8
    v_and_b32 v8, v7, v120
    v_add_f32 v141, v141, v8
    v_lshlrev_b32 v8, 16, v121
    v_add_f32 v142, v142, v8
    v_and_b32 v8, v7, v121
    v_add_f32 v143, v143, v8
    v_lshlrev_b32 v8, 16, v122
    v_add_f32 v144, v144, v8
    v_and_b32 v8, v7, v122
    v_add_f32 v145, v145, v8
    v_lshlrev_b32 v8, 16, v123
    v_add_f32 v146, v146, v8
    v_lshlrev_b32 v8, 16, v124
    v_add_f32 v140, v140, v8
    v_and_b32 v8, v7, v124
    v_add_f32 v141, v141, v8
    v_lshlrev_b32 v8, 16, v125
    v_add_f32 v142, v142, v8
    v_and_b32 v8, v7, v125
    v_add_f32 v143, v143, v8
    v_lshlrev_b32 v8, 16, v126
    v_add_f32 v144, v144, v8
    v_and_b32 v8, v7, v126
    v_add_f32 v145, v145, v8
    v_lshlrev_b32 v8, 16, v127
    v_add_f32 v146, v146, v8
    v_lshlrev_b32 v8, 16, v128
    v_add_f32 v140, v140, v8
    v_and_b32 v8, v7, v128
    v_add_f32 v141, v141, v8
    v_lshlrev_b32 v8, 16, v129
    v_add_f32 v142, v142, v8
    v_and_b32 v8, v7, v129
    v_add_f32 v143, v143, v8
    v_lshlrev_b32 v8, 16, v130
    v_add_f32 v144, v144, v8
    v_and_b32 v8, v7, v130
    v_add_f32 v145, v145, v8
    v_lshlrev_b32 v8, 16, v131
    v_add_f32 v146, v146, v8
    v_and_b32 v12, 15, v1
    v_mul_u32_u24 v12, 176, v12
    v_lshrrev_b32 v13, 4, v1
    v_lshl_add_u32 v12, v13, 3, v12
    v_add_u32 v12, 40960, v12
    s_cmp_eq_u32 s36, 1
    s_cbranch_scc1 T_O1
    s_cmp_eq_u32 s36, 2
    s_cbranch_scc1 T_O2
    v_cvt_pk_bf16_f32 v8, v140, v141
    v_cvt_pk_bf16_f32 v9, v142, v143
    v_cvt_pk_bf16_f32 v10, v144, v145
    v_cvt_pk_bf16_f32 v11, v146, v146
    ds_write_b64 v12, v[8:9] offset:0
    ds_write_b32 v12, v10 offset:32
    ds_write_b16 v12, v11 offset:36
    s_branch T_OW
T_O1:
    v_cvt_pk_bf16_f32 v11, v140, v140
    v_cvt_pk_bf16_f32 v8, v141, v142
    v_cvt_pk_bf16_f32 v9, v143, v144
    v_cvt_pk_bf16_f32 v10, v145, v146
    ds_write_b16 v12, v11 offset:38
    ds_write_b64 v12, v[8:9] offset:64
    ds_write_b32 v12, v10 offset:96
    s_branch T_OW
T_O2:
    v_cvt_pk_bf16_f32 v10, v140, v141
    v_cvt_pk_bf16_f32 v8, v142, v143
    v_cvt_pk_bf16_f32 v9, v144, v145
    ds_write_b32 v12, v10 offset:100
    ds_write_b64 v12, v[8:9] offset:128
T_OW:
    s_waitcnt lgkmcnt(0)
    s_barrier
    s_and_b32 s49, s39, 1
    s_cmp_eq_u32 s49, 0
    s_cselect_b32 s50, 10, 8
    s_mov_b32 s51, 8192
    s_cselect_b32 s51, 6554, s51
    v_mul_u32_u24 v12, s51, v0
    v_lshrrev_b32 v12, 16, v12
    v_mul_u32_u24 v13, s50, v12
    v_sub_u32 v13, v0, v13
    v_cmp_gt_u32 vcc, 16, v12
    s_and_saveexec_b64 s[58:59], vcc
    s_cbranch_execz T_OWX
    v_mul_u32_u24 v14, 176, v12
    v_lshl_add_u32 v14, v13, 4, v14
    ds_read_b128 v[8:11], v14 offset:40960
    s_lshr_b32 s50, s39, 1
    s_lshl_b32 s50, s50, 4
    s_lshl_b32 s51, s37, 6
    s_add_u32 s50, s50, s51
    v_add_u32 v12, s50, v12
    s_movk_i32 s50, 1152
    v_mul_u32_u24 v12, s50, v12
    v_lshl_add_u32 v12, v13, 4, v12
    s_mul_i32 s50, s47, 288
    s_mul_i32 s49, s49, 160
    s_add_u32 s50, s50, s49
    s_waitcnt lgkmcnt(0)
    buffer_store_dwordx4 v[8:11], v12, s[28:31], s50 offen sc1
T_OWX:
    s_mov_b64 exec, s[58:59]
T_DONE:
    s_branch K1_END
K1_RSL0:
    v_max_f32 v3, v18, v36
    v_sub_f32 v4, v36, v3
    v_exp_f32 v4, v4
    v_mov_b32 v36, v3
    v_add_f32 v37, 0x41000000, v3
    v_mul_f32 v38, v38, v4
    v_mul_f32 v39, v39, v4
    v_mul_f32 v176, v176, v4
    v_mul_f32 v177, v177, v4
    v_mul_f32 v178, v178, v4
    v_mul_f32 v179, v179, v4
    v_mul_f32 v180, v180, v4
    v_mul_f32 v181, v181, v4
    v_mul_f32 v182, v182, v4
    v_mul_f32 v183, v183, v4
    v_mul_f32 v184, v184, v4
    v_mul_f32 v185, v185, v4
    v_mul_f32 v186, v186, v4
    v_mul_f32 v187, v187, v4
    v_mul_f32 v188, v188, v4
    v_mul_f32 v189, v189, v4
    v_mul_f32 v190, v190, v4
    v_mul_f32 v191, v191, v4
    v_mul_f32 v192, v192, v4
    v_mul_f32 v193, v193, v4
    v_mul_f32 v194, v194, v4
    v_mul_f32 v195, v195, v4
    v_mul_f32 v196, v196, v4
    v_mul_f32 v197, v197, v4
    v_mul_f32 v198, v198, v4
    v_mul_f32 v199, v199, v4
    v_mul_f32 v200, v200, v4
    v_mul_f32 v201, v201, v4
    v_mul_f32 v202, v202, v4
    v_mul_f32 v203, v203, v4
    v_mul_f32 v204, v204, v4
    v_mul_f32 v205, v205, v4
    v_mul_f32 v206, v206, v4
    v_mul_f32 v207, v207, v4
    v_mul_f32 v208, v208, v4
    v_mul_f32 v209, v209, v4
    v_mul_f32 v210, v210, v4
    v_mul_f32 v211, v211, v4
    v_mul_f32 v212, v212, v4
    v_mul_f32 v213, v213, v4
    v_mul_f32 v214, v214, v4
    v_mul_f32 v215, v215, v4
    v_mul_f32 v216, v216, v4
    v_mul_f32 v217, v217, v4
    v_mul_f32 v218, v218, v4
    v_mul_f32 v219, v219, v4
    v_mul_f32 v220, v220, v4
    v_mul_f32 v221, v221, v4
    v_mul_f32 v222, v222, v4
    v_mul_f32 v223, v223, v4
    v_mul_f32 v224, v224, v4
    v_mul_f32 v225, v225, v4
    v_mul_f32 v226, v226, v4
    v_mul_f32 v227, v227, v4
    v_mul_f32 v228, v228, v4
    v_mul_f32 v229, v229, v4
    v_mul_f32 v230, v230, v4
    v_mul_f32 v231, v231, v4
    v_mul_f32 v232, v232, v4
    v_mul_f32 v233, v233, v4
    v_mul_f32 v234, v234, v4
    v_mul_f32 v235, v235, v4
    v_mul_f32 v236, v236, v4
    v_mul_f32 v237, v237, v4
    v_mul_f32 v238, v238, v4
    v_mul_f32 v239, v239, v4
    s_branch K1_BKL0
K1_RSL1:
    v_max_f32 v3, v18, v36
    v_sub_f32 v4, v36, v3
    v_exp_f32 v4, v4
    v_mov_b32 v36, v3
    v_add_f32 v37, 0x41000000, v3
    v_mul_f32 v38, v38, v4
    v_mul_f32 v39, v39, v4
    v_mul_f32 v176, v176, v4
    v_mul_f32 v177, v177, v4
    v_mul_f32 v178, v178, v4
    v_mul_f32 v179, v179, v4
    v_mul_f32 v180, v180, v4
    v_mul_f32 v181, v181, v4
    v_mul_f32 v182, v182, v4
    v_mul_f32 v183, v183, v4
    v_mul_f32 v184, v184, v4
    v_mul_f32 v185, v185, v4
    v_mul_f32 v186, v186, v4
    v_mul_f32 v187, v187, v4
    v_mul_f32 v188, v188, v4
    v_mul_f32 v189, v189, v4
    v_mul_f32 v190, v190, v4
    v_mul_f32 v191, v191, v4
    v_mul_f32 v192, v192, v4
    v_mul_f32 v193, v193, v4
    v_mul_f32 v194, v194, v4
    v_mul_f32 v195, v195, v4
    v_mul_f32 v196, v196, v4
    v_mul_f32 v197, v197, v4
    v_mul_f32 v198, v198, v4
    v_mul_f32 v199, v199, v4
    v_mul_f32 v200, v200, v4
    v_mul_f32 v201, v201, v4
    v_mul_f32 v202, v202, v4
    v_mul_f32 v203, v203, v4
    v_mul_f32 v204, v204, v4
    v_mul_f32 v205, v205, v4
    v_mul_f32 v206, v206, v4
    v_mul_f32 v207, v207, v4
    v_mul_f32 v208, v208, v4
    v_mul_f32 v209, v209, v4
    v_mul_f32 v210, v210, v4
    v_mul_f32 v211, v211, v4
    v_mul_f32 v212, v212, v4
    v_mul_f32 v213, v213, v4
    v_mul_f32 v214, v214, v4
    v_mul_f32 v215, v215, v4
    v_mul_f32 v216, v216, v4
    v_mul_f32 v217, v217, v4
    v_mul_f32 v218, v218, v4
    v_mul_f32 v219, v219, v4
    v_mul_f32 v220, v220, v4
    v_mul_f32 v221, v221, v4
    v_mul_f32 v222, v222, v4
    v_mul_f32 v223, v223, v4
    v_mul_f32 v224, v224, v4
    v_mul_f32 v225, v225, v4
    v_mul_f32 v226, v226, v4
    v_mul_f32 v227, v227, v4
    v_mul_f32 v228, v228, v4
    v_mul_f32 v229, v229, v4
    v_mul_f32 v230, v230, v4
    v_mul_f32 v231, v231, v4
    v_mul_f32 v232, v232, v4
    v_mul_f32 v233, v233, v4
    v_mul_f32 v234, v234, v4
    v_mul_f32 v235, v235, v4
    v_mul_f32 v236, v236, v4
    v_mul_f32 v237, v237, v4
    v_mul_f32 v238, v238, v4
    v_mul_f32 v239, v239, v4
    s_branch K1_BKL1
K1_RSA:
    v_max_f32 v3, v18, v36
    v_sub_f32 v4, v36, v3
    v_exp_f32 v4, v4
    v_mov_b32 v36, v3
    v_add_f32 v37, 0x41000000, v3
    v_mul_f32 v38, v38, v4
    v_mul_f32 v39, v39, v4
    v_mul_f32 v176, v176, v4
    v_mul_f32 v177, v177, v4
    v_mul_f32 v178, v178, v4
    v_mul_f32 v179, v179, v4
    v_mul_f32 v180, v180, v4
    v_mul_f32 v181, v181, v4
    v_mul_f32 v182, v182, v4
    v_mul_f32 v183, v183, v4
    v_mul_f32 v184, v184, v4
    v_mul_f32 v185, v185, v4
    v_mul_f32 v186, v186, v4
    v_mul_f32 v187, v187, v4
    v_mul_f32 v188, v188, v4
    v_mul_f32 v189, v189, v4
    v_mul_f32 v190, v190, v4
    v_mul_f32 v191, v191, v4
    v_mul_f32 v192, v192, v4
    v_mul_f32 v193, v193, v4
    v_mul_f32 v194, v194, v4
    v_mul_f32 v195, v195, v4
    v_mul_f32 v196, v196, v4
    v_mul_f32 v197, v197, v4
    v_mul_f32 v198, v198, v4
    v_mul_f32 v199, v199, v4
    v_mul_f32 v200, v200, v4
    v_mul_f32 v201, v201, v4
    v_mul_f32 v202, v202, v4
    v_mul_f32 v203, v203, v4
    v_mul_f32 v204, v204, v4
    v_mul_f32 v205, v205, v4
    v_mul_f32 v206, v206, v4
    v_mul_f32 v207, v207, v4
    v_mul_f32 v208, v208, v4
    v_mul_f32 v209, v209, v4
    v_mul_f32 v210, v210, v4
    v_mul_f32 v211, v211, v4
    v_mul_f32 v212, v212, v4
    v_mul_f32 v213, v213, v4
    v_mul_f32 v214, v214, v4
    v_mul_f32 v215, v215, v4
    v_mul_f32 v216, v216, v4
    v_mul_f32 v217, v217, v4
    v_mul_f32 v218, v218, v4
    v_mul_f32 v219, v219, v4
    v_mul_f32 v220, v220, v4
    v_mul_f32 v221, v221, v4
    v_mul_f32 v222, v222, v4
    v_mul_f32 v223, v223, v4
    v_mul_f32 v224, v224, v4
    v_mul_f32 v225, v225, v4
    v_mul_f32 v226, v226, v4
    v_mul_f32 v227, v227, v4
    v_mul_f32 v228, v228, v4
    v_mul_f32 v229, v229, v4
    v_mul_f32 v230, v230, v4
    v_mul_f32 v231, v231, v4
    v_mul_f32 v232, v232, v4
    v_mul_f32 v233, v233, v4
    v_mul_f32 v234, v234, v4
    v_mul_f32 v235, v235, v4
    v_mul_f32 v236, v236, v4
    v_mul_f32 v237, v237, v4
    v_mul_f32 v238, v238, v4
    v_mul_f32 v239, v239, v4
    s_branch K1_BKA
K1_RSB:
    v_max_f32 v3, v18, v36
    v_sub_f32 v4, v36, v3
    v_exp_f32 v4, v4
    v_mov_b32 v36, v3
    v_add_f32 v37, 0x41000000, v3
    v_mul_f32 v38, v38, v4
    v_mul_f32 v39, v39, v4
    v_mul_f32 v176, v176, v4
    v_mul_f32 v177, v177, v4
    v_mul_f32 v178, v178, v4
    v_mul_f32 v179, v179, v4
    v_mul_f32 v180, v180, v4
    v_mul_f32 v181, v181, v4
    v_mul_f32 v182, v182, v4
    v_mul_f32 v183, v183, v4
    v_mul_f32 v184, v184, v4
    v_mul_f32 v185, v185, v4
    v_mul_f32 v186, v186, v4
    v_mul_f32 v187, v187, v4
    v_mul_f32 v188, v188, v4
    v_mul_f32 v189, v189, v4
    v_mul_f32 v190, v190, v4
    v_mul_f32 v191, v191, v4
    v_mul_f32 v192, v192, v4
    v_mul_f32 v193, v193, v4
    v_mul_f32 v194, v194, v4
    v_mul_f32 v195, v195, v4
    v_mul_f32 v196, v196, v4
    v_mul_f32 v197, v197, v4
    v_mul_f32 v198, v198, v4
    v_mul_f32 v199, v199, v4
    v_mul_f32 v200, v200, v4
    v_mul_f32 v201, v201, v4
    v_mul_f32 v202, v202, v4
    v_mul_f32 v203, v203, v4
    v_mul_f32 v204, v204, v4
    v_mul_f32 v205, v205, v4
    v_mul_f32 v206, v206, v4
    v_mul_f32 v207, v207, v4
    v_mul_f32 v208, v208, v4
    v_mul_f32 v209, v209, v4
    v_mul_f32 v210, v210, v4
    v_mul_f32 v211, v211, v4
    v_mul_f32 v212, v212, v4
    v_mul_f32 v213, v213, v4
    v_mul_f32 v214, v214, v4
    v_mul_f32 v215, v215, v4
    v_mul_f32 v216, v216, v4
    v_mul_f32 v217, v217, v4
    v_mul_f32 v218, v218, v4
    v_mul_f32 v219, v219, v4
    v_mul_f32 v220, v220, v4
    v_mul_f32 v221, v221, v4
    v_mul_f32 v222, v222, v4
    v_mul_f32 v223, v223, v4
    v_mul_f32 v224, v224, v4
    v_mul_f32 v225, v225, v4
    v_mul_f32 v226, v226, v4
    v_mul_f32 v227, v227, v4
    v_mul_f32 v228, v228, v4
    v_mul_f32 v229, v229, v4
    v_mul_f32 v230, v230, v4
    v_mul_f32 v231, v231, v4
    v_mul_f32 v232, v232, v4
    v_mul_f32 v233, v233, v4
    v_mul_f32 v234, v234, v4
    v_mul_f32 v235, v235, v4
    v_mul_f32 v236, v236, v4
    v_mul_f32 v237, v237, v4
    v_mul_f32 v238, v238, v4
    v_mul_f32 v239, v239, v4
    s_branch K1_BKB
K1_END:
    s_endpgm
.section .rodata,"a"
.p2align 6
.amdhsa_kernel standalone__gqa_block_cached__near_ridge_kernel
  .amdhsa_next_free_vgpr 250
  .amdhsa_next_free_sgpr 100
  .amdhsa_accum_offset 252
  .amdhsa_group_segment_fixed_size 0
  .amdhsa_kernarg_size 64
  .amdhsa_user_sgpr_count 2
  .amdhsa_user_sgpr_kernarg_segment_ptr 1
  .amdhsa_system_sgpr_workgroup_id_x 1
  .amdhsa_float_denorm_mode_32 3
  .amdhsa_float_denorm_mode_16_64 3
.end_amdhsa_kernel
.text
```
